```python
import torch

def _softmax(x, axis=-1):
    return torch.softmax(x, dim=axis)
def _gelu(x):
    return torch.nn.functional.gelu(x, approximate="tanh")
def _silu(x):
    return torch.nn.functional.silu(x)
def _sigmoid(x):
    return torch.sigmoid(x)
def _layernorm(x, axis=-1, eps=1e-5):
    m = x.mean(dim=axis, keepdim=True)
    v = x.var(dim=axis, keepdim=True, unbiased=False)
    return (x - m) / torch.sqrt(v + eps)
def _scatter_add(tgt, idx, src, axis=0):
    return tgt.clone().index_add_(axis, idx, src)
def _segment_sum(src, seg, n):
    out = torch.zeros((n,) + src.shape[1:], dtype=src.dtype)
    return out.index_add_(0, seg, src)
def _pad(x, pw):
    flat = tuple(v for pair in reversed(pw) for v in pair)
    return torch.nn.functional.pad(x, flat)

kernel_name = 'sequential_preLN__linear_kernel_hedgehog__mixer_channel_mlp__prompt'

def setup_inputs():

    _w = (lambda a: (lambda t: t.to(torch.bfloat16) if t.is_floating_point() else t)(torch.as_tensor(a)))
    def _A_setup():
        B, S, D, H = 1, 2048, 640, 32
        Dh = D // H
        return {
            "x": _w((lambda *s: torch.randn(*s, dtype=torch.bfloat16) * 0.05)(B, S, D)),
            "wqkv": _w((lambda *s: torch.randn(*s, dtype=torch.bfloat16) * 0.2)(D, 3 * D)),
            "w_phi": _w((lambda *s: torch.randn(*s, dtype=torch.bfloat16) * 0.2)(H, Dh, Dh) * (Dh ** -0.5)),
            "wo": _w((lambda *s: torch.randn(*s, dtype=torch.bfloat16) * 0.05)(D, D)),
        }
    _A_in = _A_setup()

    def _B_setup():
        B, S, D, F = 1, 2048, 640, 1536
        return {
            "x": _w((lambda *s: torch.randn(*s, dtype=torch.bfloat16) * 0.05)(B, S, D)),
            "w1": _w((lambda *s: torch.randn(*s, dtype=torch.bfloat16) * 3.2)(D, F) * (D ** -0.5)),
            "b1": _w((lambda *s: torch.randn(*s, dtype=torch.bfloat16) * 0.8)(F)),
            "w2": _w((lambda *s: torch.randn(*s, dtype=torch.bfloat16) * 0.1)(F, D) * (F ** -0.5)),
            "b2": _w((lambda *s: torch.randn(*s, dtype=torch.bfloat16) * 0.1)(D)),
        }
    _B_in = _B_setup()

    return {
        "A_x": _A_in["x"],
        "A_wqkv": _A_in["wqkv"],
        "A_w_phi": _A_in["w_phi"],
        "A_wo": _A_in["wo"],
        "B_x": _B_in["x"],
        "B_w1": _B_in["w1"],
        "B_b1": _B_in["b1"],
        "B_w2": _B_in["w2"],
        "B_b2": _B_in["b2"],
    }

def reference(A_x, A_wqkv, A_w_phi, A_wo, B_x, B_w1, B_b1, B_w2, B_b2):
    def _A_ref(x, wqkv, w_phi, wo):
        B, S, D = x.shape
        H = 32; Dh = D // H
        qkv = (lambda x, *d: x.permute(*d))((x @ wqkv).reshape(B, S, 3, H, Dh), 2, 0, 3, 1, 4)
        q, k, v = qkv[0], qkv[1], qkv[2]
        pq = torch.einsum("bhsd,hdf->bhsf", q, w_phi)
        pk = torch.einsum("bhsd,hdf->bhsf", k, w_phi)
        phi_q = torch.concatenate([_softmax(pq, axis=-1), _softmax(-pq, axis=-1)], axis=-1)
        phi_k = torch.concatenate([_softmax(pk, axis=-1), _softmax(-pk, axis=-1)], axis=-1)
        kv = torch.einsum("bhsf,bhsd->bhfd", phi_k, v)
        z  = torch.einsum("bhsf->bhf", phi_k)
        num = torch.einsum("bhqf,bhfd->bhqd", phi_q, kv)
        den = torch.einsum("bhqf,bhf->bhq", phi_q, z)[..., None] + 1e-6
        o = num / den
        return (lambda x, *d: x.permute(*d))(o, 0, 2, 1, 3).reshape(B, S, D) @ wo

    def _B_ref(x, w1, b1, w2, b2):
        y = _layernorm(x, axis=-1)
        h = _gelu(torch.einsum("bsd,df->bsf", y, w1) + b1)
        return torch.einsum("bsf,fd->bsd", h, w2) + b2

    x = A_x
    h = x + _A_ref(_layernorm(x, axis=-1), A_wqkv, A_w_phi, A_wo)
    h2 = h + _B_ref(_layernorm(h, axis=-1), B_w1, B_b1, B_w2, B_b2)
    return h2
```

```asm
; @launch grid=(256,1,1) block=(256,1,1) lds=163840
.amdgcn_target "amdgcn-amd-amdhsa--gfx950"
.text
.globl sequential_preLN__linear_kernel_hedgehog__mixer_channel_mlp__prompt_kernel
.p2align 8
.type sequential_preLN__linear_kernel_hedgehog__mixer_channel_mlp__prompt_kernel,@function
sequential_preLN__linear_kernel_hedgehog__mixer_channel_mlp__prompt_kernel:
    s_cmp_ge_u32 s2, 256
    s_cbranch_scc1 L_end
    s_load_dwordx2 s[8:9], s[0:1], 0
    s_load_dwordx2 s[12:13], s[0:1], 8
    s_load_dwordx2 s[16:17], s[0:1], 88
    s_load_dwordx2 s[36:37], s[0:1], 16
    s_load_dwordx2 s[40:41], s[0:1], 80
    s_load_dwordx2 s[20:21], s[0:1], 24
    s_load_dwordx2 s[24:25], s[0:1], 40
    s_load_dwordx2 s[28:29], s[0:1], 56
    s_load_dwordx2 s[32:33], s[0:1], 72
    s_load_dwordx2 s[44:45], s[0:1], 48
    s_load_dwordx2 s[48:49], s[0:1], 64
    v_lshrrev_b32 v2, 6, v0
    v_and_b32 v1, 63, v0
    v_readfirstlane_b32 s52, v2
    s_and_b32 s59, s2, 7
    s_lshr_b32 s60, s2, 3
    s_and_b32 s54, s59, 3
    s_lshl_b32 s54, s54, 2
    s_and_b32 s61, s60, 3
    s_add_u32 s54, s54, s61
    s_lshr_b32 s53, s59, 2
    s_lshl_b32 s53, s53, 3
    s_lshr_b32 s61, s60, 2
    s_add_u32 s53, s53, s61
    s_and_b32 s61, s53, 15
    s_mul_i32 s61, s61, 12
    s_lshr_b32 s62, s54, 2
    s_mul_i32 s62, s62, 10
    s_add_u32 s61, s61, s62
    s_lshr_b32 s61, s61, 2
    s_mul_i32 s62, s61, 6554
    s_lshr_b32 s62, s62, 16
    s_mul_i32 s62, s62, 10
    s_sub_u32 s61, s61, s62
    s_lshl_b32 s80, s61, 7
    s_add_u32 s81, s80, 128
    s_cmp_eq_u32 s81, 1280
    s_cselect_b32 s81, 0, s81
    s_lshl_b32 s61, s53, 2
    s_add_u32 s61, s61, s52
    s_mul_i32 s61, s61, 40960
    v_lshrrev_b32 v2, 3, v1
    v_mul_u32_u24 v2, 1280, v2
    v_lshrrev_b32 v3, 4, v1
    v_xor_b32 v3, v3, v1
    v_and_b32 v3, 7, v3
    v_lshlrev_b32 v3, 4, v3
    v_add3_u32 v6, v2, v3, s61
    v_xor_b32 v7, 64, v6
    v_add_u32 v7, 9216, v7
    v_add_u32 v8, 18432, v6
    v_add_u32 v9, 18432, v7
    s_mul_i32 s61, s52, 61440
    s_mul_i32 s62, s54, 80
    s_add_u32 s61, s61, s62
    s_add_u32 s61, s61, 1280
    v_lshlrev_b32 v13, 4, v1
    v_add_u32 v5, s61, v13
    v_mul_u32_u24 v2, 13108, v1
    s_movk_i32 s59, 1200
    s_movk_i32 s60, 12800
    s_movk_i32 s61, -26880
    s_movk_i32 s62, 15360
    v_lshrrev_b32 v3, 16, v2
    v_mad_i32_i24 v10, v3, s59, v5
    v_lshrrev_b32 v3, 17, v2
    v_mad_i32_i24 v10, v3, s60, v10
    v_lshrrev_b32 v3, 18, v2
    v_mad_i32_i24 v10, v3, s61, v10
    v_lshrrev_b32 v3, 20, v2
    v_mad_i32_i24 v10, v3, s62, v10
    v_add_u32 v2, 838912, v2
    v_lshrrev_b32 v3, 16, v2
    v_mad_i32_i24 v11, v3, s59, v5
    v_lshrrev_b32 v3, 17, v2
    v_mad_i32_i24 v11, v3, s60, v11
    v_lshrrev_b32 v3, 18, v2
    v_mad_i32_i24 v11, v3, s61, v11
    v_lshrrev_b32 v3, 20, v2
    v_mad_i32_i24 v11, v3, s62, v11
    v_add_u32 v2, 838912, v2
    v_lshrrev_b32 v3, 16, v2
    v_mad_i32_i24 v12, v3, s59, v5
    v_lshrrev_b32 v3, 17, v2
    v_mad_i32_i24 v12, v3, s60, v12
    v_lshrrev_b32 v3, 18, v2
    v_mad_i32_i24 v12, v3, s61, v12
    v_lshrrev_b32 v3, 20, v2
    v_mad_i32_i24 v12, v3, s62, v12
    s_lshl_b32 s94, s52, 12
    s_add_u32 s94, s94, 104192
    s_mul_i32 s95, s52, 2560
    s_getpc_b64 s[4:5]
L_pc:
    s_and_b32 s4, s4, 0xffffff00
    s_mov_b32 s6, L_end-L_pc
    s_mov_b32 s7, 0x20000
    s_lshr_b32 s59, s2, 3
    s_lshl_b32 s59, s59, 2
    s_add_u32 s59, s59, s52
    s_lshl_b32 s59, s59, 7
    v_lshl_add_u32 v2, v1, 14, s59
    s_mov_b64 exec, 7
    buffer_load_dword v14, v2, s[4:7], 0 offen
    s_mov_b64 exec, -1
    s_mov_b32 s10, 2621440
    s_mov_b32 s11, 0x20000
    s_mov_b32 s14, 2457600
    s_mov_b32 s15, 0x20000
    s_waitcnt lgkmcnt(0)
    s_add_u32 m0, s94, 0
    s_nop 0
    buffer_load_dwordx4 v6, s[8:11], s80 offen offset:0 lds
    buffer_load_dwordx4 v7, s[8:11], s80 offen offset:1024 lds
    buffer_load_dwordx4 v8, s[8:11], s80 offen offset:2048 lds
    buffer_load_dwordx4 v9, s[8:11], s80 offen offset:3072 lds
    s_mul_i32 s80, s80, 1920
    s_add_u32 m0, s95, 0
    s_nop 0
    buffer_load_dwordx4 v10, s[12:15], s80 offen offset:0 lds
    buffer_load_dwordx4 v11, s[12:15], s80 offen offset:1024 lds
    s_mov_b32 exec_hi, 0
    buffer_load_dwordx4 v12, s[12:15], s80 offen offset:2048 lds
    s_mov_b32 exec_hi, -1
    s_mov_b32 s18, 268435456
    s_mov_b32 s19, 0x20000
    s_mov_b32 s38, 25600
    s_mov_b32 s39, 0x20000
    s_mov_b32 s42, 256
    s_mov_b32 s43, 0x20000
    s_mov_b32 s22, 819200
    s_mov_b32 s23, 0x20000
    s_mov_b32 s26, 1966080
    s_mov_b32 s27, 0x20000
    s_mov_b32 s30, 1966080
    s_mov_b32 s31, 0x20000
    s_mov_b32 s34, 2621440
    s_mov_b32 s35, 0x20000
    s_mov_b32 s46, 3072
    s_mov_b32 s47, 0x20000
    s_mov_b32 s50, 1280
    s_mov_b32 s51, 0x20000
    s_add_u32 s82, s81, 128
    s_cmp_eq_u32 s82, 1280
    s_cselect_b32 s82, 0, s82
    s_add_u32 s83, s82, 128
    s_cmp_eq_u32 s83, 1280
    s_cselect_b32 s83, 0, s83
    s_add_u32 s84, s83, 128
    s_cmp_eq_u32 s84, 1280
    s_cselect_b32 s84, 0, s84
    s_add_u32 s85, s84, 128
    s_cmp_eq_u32 s85, 1280
    s_cselect_b32 s85, 0, s85
    s_add_u32 s86, s85, 128
    s_cmp_eq_u32 s86, 1280
    s_cselect_b32 s86, 0, s86
    s_add_u32 s87, s86, 128
    s_cmp_eq_u32 s87, 1280
    s_cselect_b32 s87, 0, s87
    s_add_u32 s88, s87, 128
    s_cmp_eq_u32 s88, 1280
    s_cselect_b32 s88, 0, s88
    s_add_u32 s89, s88, 128
    s_cmp_eq_u32 s89, 1280
    s_cselect_b32 s89, 0, s89
    v_mov_b32 v198, 0x3f803f80
    v_mov_b32 v199, 0x3f803f80
    v_mov_b32 v200, 0
    v_mov_b32 v201, 0
    v_mov_b32 v202, 0
    v_mov_b32 v203, 0
    v_mov_b32 v15, 1
    v_lshrrev_b32 v19, 5, v1
    v_bfe_u32 v20, v1, 2, 2
    v_and_b32 v22, 31, v1
    v_lshlrev_b32 v16, 2, v22
    v_bfe_u32 v2, v1, 4, 1
    v_and_b32 v3, 3, v1
    v_lshl_add_u32 v21, v2, 2, v3
    v_or_b32 v21, 0x0c0c0c00, v21
    v_lshrrev_b32 v2, 1, v1
    v_mul_u32_u24 v2, 10096, v2
    v_mul_u32_u24 v3, 160, v1
    v_add_u32 v2, v2, v3
    v_mov_b32 v3, 155200
    s_mov_b64 exec, 0xfffff
    ds_write_b128 v2, v[198:201] offset:10240
    ds_write_b128 v3, v[200:203]
    s_mov_b64 exec, -1
    v_bfe_u32 v2, v1, 1, 3
    v_xor_b32 v2, v2, v19
    s_lshl_b32 s59, s52, 1
    v_xor_b32 v2, s59, v2
    v_lshlrev_b32 v2, 4, v2
    v_lshl_add_u32 v2, v22, 7, v2
    v_add_u32 v204, s94, v2
    v_xor_b32 v205, 32, v204
    v_xor_b32 v206, 64, v204
    v_xor_b32 v207, 96, v204
    v_lshlrev_b32 v2, 2, v19
    v_add_u32 v2, v2, v20
    v_mul_u32_u24 v2, 320, v2
    s_mov_b32 s63, 0x8040703
    v_mov_b32 v4, 0x6020501
    v_perm_b32 v3, s63, v4, v21
    v_lshl_add_u32 v208, v3, 3, v2
    s_mov_b32 s63, 0x130e120d
    v_mov_b32 v4, 0xf0c0900
    v_perm_b32 v3, s63, v4, v21
    v_lshl_add_u32 v209, v3, 3, v2
    s_mov_b32 s63, 0x0
    v_mov_b32 v4, 0x110b100a
    v_perm_b32 v3, s63, v4, v21
    v_lshl_add_u32 v210, v3, 3, v2
    v_and_b32 v5, 2, v1
    v_lshlrev_b32 v5, 2, v5
    v_add_u32 v5, 10240, v5
    s_mov_b32 vcc_lo, 0xffff0000
    s_mov_b32 vcc_hi, 0xffff0000
    s_xor_b32 s59, s52, 3
    s_mul_i32 s59, s59, 2560
    v_add_u32 v217, s59, v208
    v_add_u32 v218, s59, v209
    v_add_u32 v219, s59, v210
    v_cndmask_b32 v219, v219, v5, vcc
    s_xor_b32 s59, s52, 2
    s_mul_i32 s59, s59, 2560
    v_add_u32 v214, s59, v208
    v_add_u32 v215, s59, v209
    v_add_u32 v216, s59, v210
    v_cndmask_b32 v216, v216, v5, vcc
    s_xor_b32 s59, s52, 1
    s_mul_i32 s59, s59, 2560
    v_add_u32 v211, s59, v208
    v_add_u32 v212, s59, v209
    v_add_u32 v213, s59, v210
    v_cndmask_b32 v213, v213, v5, vcc
    s_xor_b32 s59, s52, 0
    s_mul_i32 s59, s59, 2560
    v_add_u32 v208, s59, v208
    v_add_u32 v209, s59, v209
    v_add_u32 v210, s59, v210
    v_cndmask_b32 v210, v210, v5, vcc
    s_mov_b32 vcc_lo, 0xf0f00f0f
    s_mov_b32 vcc_hi, 0xf0f00f0f
    v_cndmask_b32 v28, v200, v198, vcc
    v_cndmask_b32 v29, v200, v198, vcc
    v_cndmask_b32 v30, v200, v198, vcc
    v_cndmask_b32 v31, v200, v198, vcc
    s_mov_b32 s90, -1
    s_mov_b32 s91, 0
    s_and_b32 s98, s52, 1
    s_lshr_b32 s99, s52, 1
    s_and_b32 s59, s2, 7
    s_lshr_b32 s60, s2, 3
    s_lshl_b32 s55, s59, 1
    s_lshr_b32 s61, s60, 4
    s_add_u32 s55, s55, s61
    s_and_b32 s56, s60, 15
    s_and_b32 s57, s56, 7
    s_lshr_b32 s58, s56, 3
    s_mov_b32 s0, s55
    s_lshr_b32 s0, s59, 1
    s_lshl_b32 s0, s0, 2
    s_lshr_b32 s61, s60, 3
    s_add_u32 s0, s0, s61
    s_and_b32 s56, s59, 1
    s_lshl_b32 s56, s56, 3
    s_add_u32 s56, s56, s57
    s_and_b32 s59, s54, 7
    s_lshr_b32 s61, 0xa5, s59
    s_lshr_b32 s59, s54, 1
    s_lshl_b32 s59, s59, 4
    s_add_u32 s59, s59, s53
    s_lshl_b32 s64, s59, 2
    s_add_u32 s64, s64, s52
    s_bitcmp1_b32 s61, 0
    s_cselect_b32 s64, s64, 1000
    s_lshl_b32 s3, s53, 1
    s_lshr_b32 s3, 0x24924924, s3
    s_and_b32 s3, s3, 3
    s_cmp_lt_u32 s64, 512
    s_cselect_b32 s3, s3, 9
    s_mul_i32 s60, s64, 6554
    s_lshr_b32 s60, s60, 16
    s_mul_i32 s61, s60, 10
    s_sub_u32 s59, s64, s61
    s_mul_i32 s61, s60, 5
    s_mul_i32 s60, s60, 6
    s_sub_u32 s60, s60, 96
    s_cmp_lt_u32 s64, 160
    s_cselect_b64 s[4:5], s[20:21], s[28:29]
    s_cselect_b32 s6, s22, s30
    s_cselect_b32 s74, s61, s60
    s_cselect_b32 s76, 4, 5
    s_cselect_b32 s62, 0, 102400
    s_mov_b32 s7, 0x20000
    s_add_u32 s76, s76, s74
    s_lshl_b32 s61, s59, 7
    v_lshrrev_b32 v2, 3, v1
    v_mul_u32_u24 v2, 1152, v2
    v_add3_u32 v253, v2, v13, s61
    v_lshrrev_b32 v3, 4, v1
    s_lshl_b32 s59, s59, 2
    v_add_u32 v4, s59, v3
    v_and_b32 v5, 0xf0, v13
    v_lshl_add_u32 v5, v4, 10, v5
    v_mul_u32_u24 v4, 13108, v4
    v_lshrrev_b32 v4, 16, v4
    v_mul_u32_u24 v4, 343040, v4
    v_add3_u32 v254, v4, v5, s62
    s_mul_i32 s75, s52, 6144
    s_add_u32 s75, s75, 52224
    v_lshlrev_b32 v2, 7, v20
    v_lshl_add_u32 v2, v3, 5, v2
    v_and_b32 v5, 3, v1
    v_lshlrev_b32 v5, 3, v5
    v_add3_u32 v255, v2, v5, s75
    s_mul_i32 s61, s54, 80
    s_movk_i32 s63, 3840
    s_lshl_b32 s59, s52, 6
    v_add_u32 v2, s59, v1
    v_mul_u32_u24 v3, 13108, v2
    v_lshrrev_b32 v3, 16, v3
    v_mul_u32_u24 v4, 5, v3
    v_sub_u32 v2, v2, v4
    v_bfe_u32 v4, v3, 2, 2
    v_and_or_b32 v4, v3, 48, v4
    v_and_b32 v3, 3, v3
    v_lshl_add_u32 v4, v3, 2, v4
    v_lshlrev_b32 v2, 4, v2
    v_mad_u32_u24 v2, v4, s63, v2
    v_add_u32 v154, s61, v2
    v_add_u32 v2, 256, v1
    v_mul_u32_u24 v3, 13108, v2
    v_lshrrev_b32 v3, 16, v3
    v_mul_u32_u24 v4, 5, v3
    v_sub_u32 v2, v2, v4
    v_bfe_u32 v4, v3, 2, 2
    v_and_or_b32 v4, v3, 48, v4
    v_and_b32 v3, 3, v3
    v_lshl_add_u32 v4, v3, 2, v4
    v_lshlrev_b32 v2, 4, v2
    v_mad_u32_u24 v2, v4, s63, v2
    v_add_u32 v155, s61, v2
    s_lshl_b32 s65, s52, 10
    s_add_u32 s59, s52, 0
    s_min_u32 s59, s59, 9
    s_mul_i32 s66, s59, 5216
    s_mul_i32 s59, s59, 245760
    s_add_u32 s59, s59, s80
    s_sub_u32 s60, s59, 2457600
    s_min_u32 s67, s59, s60
    s_add_u32 s59, s52, 4
    s_min_u32 s59, s59, 9
    s_mul_i32 s68, s59, 5216
    s_mul_i32 s59, s59, 245760
    s_add_u32 s59, s59, s80
    s_cmp_lg_u32 s54, 0
    s_cbranch_scc1 L_nz1
    s_lshl_b32 s96, s53, 2
    s_add_u32 s96, s96, s52
    s_lshl_b32 s96, s96, 10
    buffer_store_dwordx4 v[200:203], v13, s[16:19], s96 offen sc1
L_nz1:
    s_mul_i32 s96, s52, 400
    s_mul_i32 s97, s54, 1600
    s_add_u32 s97, s97, s96
    s_add_u32 m0, s96, 153600
    s_mov_b64 exec, 0x1ffffff
    buffer_load_dwordx4 v13, s[36:39], s97 offen lds
    s_mov_b64 exec, -1
    s_mov_b32 m0, 155216
    s_mul_i32 s96, s56, 192
    s_mov_b64 exec, 0xfff
    buffer_load_dwordx4 v13, s[44:47], s96 offen lds
    s_mov_b32 m0, 155408
    s_mul_i32 s96, s57, 160
    s_mov_b64 exec, 0x3ff
    buffer_load_dwordx4 v13, s[48:51], s96 offen lds
    s_mov_b64 exec, -1
    s_add_u32 m0, s94, 16384
    s_nop 0
    buffer_load_dwordx4 v6, s[8:11], s81 offen offset:0 lds
    s_sub_u32 s60, s59, 2457600
    s_min_u32 s69, s59, s60
    s_add_u32 s59, s52, 8
    s_min_u32 s59, s59, 9
    s_mul_i32 s70, s59, 5216
    s_mul_i32 s59, s59, 245760
    s_add_u32 s59, s59, s80
    s_sub_u32 s60, s59, 2457600
    s_min_u32 s71, s59, s60
    v_add_u32 v45, 155648, v13
    buffer_load_dwordx4 v7, s[8:11], s81 offen offset:1024 lds
    v_add_u32 v44, s65, v45
    v_mov_b32 v26, 0
    v_mov_b32 v27, 0
    v_mov_b32 v66, 0
    v_mov_b32 v67, 0
    v_mov_b32 v100, 0
    v_mov_b32 v101, 0
    v_mov_b32 v174, v198
    v_mov_b32 v175, v198
    s_lshl_b32 s59, s52, 5
    buffer_load_dwordx4 v8, s[8:11], s81 offen offset:2048 lds
    v_lshl_add_u32 v2, v19, 7, v22
    v_add_u32 v2, s59, v2
    v_mul_u32_u24 v153, 80, v2
    v_mul_u32_u24 v176, 48, v2
    v_add_u32 v153, 104192, v153
    v_add_u32 v176, 124672, v176
    v_lshlrev_b32 v2, 1, v20
    v_add_lshl_u32 v2, v2, v19, 1
    v_mul_u32_u24 v5, 80, v2
    s_lshl_b32 s59, s99, 7
    buffer_load_dwordx4 v9, s[8:11], s81 offen offset:3072 lds
    s_mul_i32 s81, s81, 1920
    v_add_u32 v2, s59, v2
    s_mov_b32 s62, 0x6010500
    s_mov_b32 s63, 0x7020702
    s_cmp_eq_u32 s98, 0
    s_cselect_b32 s62, s62, 0x9040803
    s_cselect_b32 s63, s63, 0x9040904
    v_mov_b32 v4, s62
    v_perm_b32 v3, s63, v4, v21
    v_mul_u32_u24 v177, 80, v2
    s_add_u32 m0, s95, 10416
    v_lshl_add_u32 v177, v3, 3, v177
    buffer_load_dwordx4 v10, s[12:15], s81 offen offset:0 lds
    v_add_u32 v177, 104192, v177
    s_mov_b32 s62, 0x1000403
    s_mov_b32 s63, 0x5050502
    s_cmp_eq_u32 s99, 0
    s_cselect_b32 s62, s62, 0x1040300
    s_cselect_b32 s63, s63, 0x5050502
    v_mov_b32 v4, s62
    v_perm_b32 v3, s63, v4, v21
    v_lshlrev_b32 v3, 3, v3
    v_mad_u32_u24 v178, v2, 48, v3
    buffer_load_dwordx4 v11, s[12:15], s81 offen offset:1024 lds
    v_add_u32 v178, 124672, v178
    v_mad_u32_u24 v181, v19, 24, v22
    v_lshlrev_b32 v180, 4, v181
    v_lshlrev_b32 v181, 3, v181
    s_lshl_b32 s59, s54, 4
    s_add_u32 s59, s59, s53
    s_lshl_b32 s59, s59, 1
    s_add_u32 s59, s59, s99
    s_mul_i32 s59, s59, 1920
    s_add_u32 s77, s59, 1048576
    s_mov_b32 exec_hi, 0
    buffer_load_dwordx4 v12, s[12:15], s81 offen offset:2048 lds
    s_mov_b32 exec_hi, -1
    s_mul_i32 s60, s98, 768
    s_add_u32 s78, s60, s77
    s_mov_b32 s63, 0x8040703
    v_mov_b32 v4, 0x6020501
    v_perm_b32 v3, s63, v4, v21
    v_lshl_add_u32 v156, v3, 3, v5
    v_bfe_u32 v3, v1, 1, 1
    v_mul_u32_u24 v3, 72, v3
    v_add_u32 v157, v3, v5
    s_mov_b32 vcc_lo, 0xaaaa5555
    s_mov_b64 exec, 0
    s_cmp_eq_u32 s52, 0
    s_cbranch_scc1 L_pad0
    s_cmp_eq_u32 s52, 1
    s_cbranch_scc1 L_pad1
    s_cmp_eq_u32 s52, 2
    s_cbranch_scc1 L_pad2
    s_branch L_pad3
    .p2align 12
L_padret:
    s_mov_b64 exec, -1
    s_waitcnt vmcnt(10) lgkmcnt(0)
    s_barrier
    ds_read_b128 a[0:3], v204 offset:0
    ds_read_b64_tr_b16 a[160:161], v208 offset:0
    ds_read_b64_tr_b16 a[162:163], v208 offset:160
    ds_read_b64_tr_b16 a[164:165], v209 offset:0
    ds_read_b64_tr_b16 a[166:167], v209 offset:160
    ds_read_b64_tr_b16 a[168:169], v210 offset:0
    ds_read_b64_tr_b16 a[170:171], v210 offset:160
    ds_read_b128 a[4:7], v205 offset:0
    ds_read_b64_tr_b16 a[172:173], v211 offset:0
    ds_read_b64_tr_b16 a[174:175], v211 offset:160
    ds_read_b64_tr_b16 a[176:177], v212 offset:0
    ds_read_b64_tr_b16 a[178:179], v212 offset:160
    ds_read_b64_tr_b16 a[180:181], v213 offset:0
    ds_read_b64_tr_b16 a[182:183], v213 offset:160
    s_waitcnt lgkmcnt(11)
    v_mfma_f32_32x32x16_bf16 v[102:117], a[160:163], a[0:3], 0
    ds_read_b128 a[8:11], v206 offset:0
    ds_read_b64_tr_b16 a[184:185], v214 offset:0
    ds_read_b64_tr_b16 a[186:187], v214 offset:160
    s_mov_b32 vcc_hi, 0xaaaa5555
    s_waitcnt lgkmcnt(12)
    v_mfma_f32_32x32x16_bf16 v[118:133], a[164:167], a[0:3], 0
    ds_read_b64_tr_b16 a[188:189], v215 offset:0
    s_add_u32 m0, s94, 32768
    ds_read_b64_tr_b16 a[190:191], v215 offset:160
    buffer_load_dwordx4 v6, s[8:11], s82 offen offset:0 lds
    s_waitcnt lgkmcnt(12)
    v_mfma_f32_32x32x16_bf16 v[134:149], a[168:171], a[0:3], 0
    ds_read_b64_tr_b16 a[192:193], v216 offset:0
    ds_read_b64_tr_b16 a[194:195], v216 offset:160
    buffer_load_dwordx4 v7, s[8:11], s82 offen offset:1024 lds
    s_waitcnt lgkmcnt(11)
    v_mfma_f32_32x32x16_bf16 v[102:117], a[172:175], a[4:7], v[102:117]
    ds_read_b128 a[12:15], v207 offset:0
    ds_read_b64_tr_b16 a[196:197], v217 offset:0
    ds_read_b64_tr_b16 a[198:199], v217 offset:160
    v_mov_b32 v4, 5120
    s_waitcnt lgkmcnt(12)
    v_mfma_f32_32x32x16_bf16 v[118:133], a[176:179], a[4:7], v[118:133]
    ds_read_b64_tr_b16 a[200:201], v218 offset:0
    ds_read_b64_tr_b16 a[202:203], v218 offset:160
    buffer_load_dwordx4 v8, s[8:11], s82 offen offset:2048 lds
    s_waitcnt lgkmcnt(12)
    v_mfma_f32_32x32x16_bf16 v[134:149], a[180:183], a[4:7], v[134:149]
    ds_read_b64_tr_b16 a[204:205], v219 offset:0
    ds_read_b64_tr_b16 a[206:207], v219 offset:160
    buffer_load_dwordx4 v9, s[8:11], s82 offen offset:3072 lds
    s_mul_i32 s82, s82, 1920
    s_waitcnt lgkmcnt(11)
    v_mfma_f32_32x32x16_bf16 v[102:117], a[184:187], a[8:11], v[102:117]
    s_add_u32 m0, s95, 20832
    s_nop 0
    buffer_load_dwordx4 v10, s[12:15], s82 offen offset:0 lds
    s_xor_b32 s59, s52, 3
    s_mul_i32 s59, s59, 1280
    v_add_u32 v162, s59, v156
    s_waitcnt lgkmcnt(9)
    v_mfma_f32_32x32x16_bf16 v[118:133], a[188:191], a[8:11], v[118:133]
    buffer_load_dwordx4 v11, s[12:15], s82 offen offset:1024 lds
    v_add_u32 v3, s59, v157
    v_cndmask_b32 v163, v4, v3, vcc
    s_xor_b32 s59, s52, 2
    s_waitcnt lgkmcnt(7)
    v_mfma_f32_32x32x16_bf16 v[134:149], a[192:195], a[8:11], v[134:149]
    s_mov_b32 exec_hi, 0
    buffer_load_dwordx4 v12, s[12:15], s82 offen offset:2048 lds
    s_mov_b32 exec_hi, -1
    s_mul_i32 s59, s59, 1280
    v_add_u32 v160, s59, v156
    v_add_u32 v3, s59, v157
    s_waitcnt vmcnt(7) lgkmcnt(0)
    s_barrier
    v_mfma_f32_32x32x16_bf16 v[102:117], a[196:199], a[12:15], v[102:117]
    ds_read_b128 a[16:19], v204 offset:16384
    ds_read_b64_tr_b16 a[160:161], v208 offset:10416
    ds_read_b64_tr_b16 a[162:163], v208 offset:10576
    ds_read_b64_tr_b16 a[164:165], v209 offset:10416
    v_mfma_f32_32x32x16_bf16 v[118:133], a[200:203], a[12:15], v[118:133]
    ds_read_b64_tr_b16 a[166:167], v209 offset:10576
    ds_read_b64_tr_b16 a[168:169], v210 offset:10416
    ds_read_b64_tr_b16 a[170:171], v210 offset:10576
    ds_read_b128 a[20:23], v205 offset:16384
    v_mfma_f32_32x32x16_bf16 v[134:149], a[204:207], a[12:15], v[134:149]
    ds_read_b64_tr_b16 a[172:173], v211 offset:10416
    ds_read_b64_tr_b16 a[174:175], v211 offset:10576
    ds_read_b64_tr_b16 a[176:177], v212 offset:10416
    v_mfma_f32_16x16x32_bf16 v[32:35], v[28:31], a[196:199], 0
    ds_read_b64_tr_b16 a[178:179], v212 offset:10576
    v_mfma_f32_16x16x32_bf16 v[36:39], v[28:31], a[200:203], 0
    ds_read_b64_tr_b16 a[180:181], v213 offset:10416
    v_mfma_f32_16x16x32_bf16 v[40:43], v[28:31], a[204:207], 0
    ds_read_b64_tr_b16 a[182:183], v213 offset:10576
    v_mfma_f32_4x4x4_16b_bf16 v[220:223], a[0:1], a[0:1], 0
    v_mfma_f32_4x4x4_16b_bf16 v[224:227], a[2:3], a[2:3], 0
    v_mfma_f32_4x4x4_16b_bf16 v[228:231], a[4:5], a[4:5], 0
    v_mfma_f32_4x4x4_16b_bf16 v[232:235], a[6:7], a[6:7], 0
    v_mfma_f32_4x4x4_16b_bf16 v[220:223], a[8:9], a[8:9], v[220:223]
    v_mfma_f32_4x4x4_16b_bf16 v[224:227], a[10:11], a[10:11], v[224:227]
    v_mfma_f32_4x4x4_16b_bf16 v[228:231], a[12:13], a[12:13], v[228:231]
    v_mfma_f32_4x4x4_16b_bf16 v[232:235], a[14:15], a[14:15], v[232:235]
    s_waitcnt lgkmcnt(0)
    v_mfma_f32_32x32x16_bf16 v[102:117], a[160:163], a[16:19], v[102:117]
    ds_read_b128 a[24:27], v206 offset:16384
    ds_read_b64_tr_b16 a[184:185], v214 offset:10416
    ds_read_b64_tr_b16 a[186:187], v214 offset:10576
    v_cndmask_b32 v161, v4, v3, vcc
    v_mfma_f32_32x32x16_bf16 v[118:133], a[164:167], a[16:19], v[118:133]
    ds_read_b64_tr_b16 a[188:189], v215 offset:10416
    s_add_u32 m0, s94, 0
    ds_read_b64_tr_b16 a[190:191], v215 offset:10576
    buffer_load_dwordx4 v6, s[8:11], s83 offen offset:0 lds
    v_mfma_f32_32x32x16_bf16 v[134:149], a[168:171], a[16:19], v[134:149]
    ds_read_b64_tr_b16 a[192:193], v216 offset:10416
    ds_read_b64_tr_b16 a[194:195], v216 offset:10576
    buffer_load_dwordx4 v7, s[8:11], s83 offen offset:1024 lds
    v_mfma_f32_32x32x16_bf16 v[102:117], a[172:175], a[20:23], v[102:117]
    ds_read_b128 a[28:31], v207 offset:16384
    ds_read_b64_tr_b16 a[196:197], v217 offset:10416
    ds_read_b64_tr_b16 a[198:199], v217 offset:10576
    s_xor_b32 s59, s52, 1
    v_mfma_f32_32x32x16_bf16 v[118:133], a[176:179], a[20:23], v[118:133]
    ds_read_b64_tr_b16 a[200:201], v218 offset:10416
    ds_read_b64_tr_b16 a[202:203], v218 offset:10576
    buffer_load_dwordx4 v8, s[8:11], s83 offen offset:2048 lds
    v_mfma_f32_32x32x16_bf16 v[134:149], a[180:183], a[20:23], v[134:149]
    ds_read_b64_tr_b16 a[204:205], v219 offset:10416
    ds_read_b64_tr_b16 a[206:207], v219 offset:10576
    buffer_load_dwordx4 v9, s[8:11], s83 offen offset:3072 lds
    s_mul_i32 s83, s83, 1920
    s_waitcnt lgkmcnt(7)
    v_mfma_f32_32x32x16_bf16 v[102:117], a[184:187], a[24:27], v[102:117]
    s_add_u32 m0, s95, 31248
    s_nop 0
    buffer_load_dwordx4 v10, s[12:15], s83 offen offset:0 lds
    s_mul_i32 s59, s59, 1280
    v_add_u32 v158, s59, v156
    v_add_u32 v3, s59, v157
    v_mfma_f32_32x32x16_bf16 v[118:133], a[188:191], a[24:27], v[118:133]
    buffer_load_dwordx4 v11, s[12:15], s83 offen offset:1024 lds
    v_cndmask_b32 v159, v4, v3, vcc
    s_xor_b32 s59, s52, 0
    s_mul_i32 s59, s59, 1280
    v_mfma_f32_32x32x16_bf16 v[134:149], a[192:195], a[24:27], v[134:149]
    s_mov_b32 exec_hi, 0
    buffer_load_dwordx4 v12, s[12:15], s83 offen offset:2048 lds
    s_mov_b32 exec_hi, -1
    v_add_u32 v156, s59, v156
    v_add_u32 v3, s59, v157
    v_cndmask_b32 v157, v4, v3, vcc
    s_or_b32 s96, s54, s52
    s_cbranch_scc1 L_ni2
    s_mov_b64 exec, 1
    buffer_atomic_add v15, off, s[40:43], 0 sc1
    s_mov_b64 exec, -1
L_ni2:
    s_waitcnt vmcnt(7) lgkmcnt(0)
    s_barrier
    v_mfma_f32_32x32x16_bf16 v[102:117], a[196:199], a[28:31], v[102:117]
    ds_read_b128 a[32:35], v204 offset:32768
    ds_read_b64_tr_b16 a[160:161], v208 offset:20832
    ds_read_b64_tr_b16 a[162:163], v208 offset:20992
    ds_read_b64_tr_b16 a[164:165], v209 offset:20832
    v_mfma_f32_32x32x16_bf16 v[118:133], a[200:203], a[28:31], v[118:133]
    ds_read_b64_tr_b16 a[166:167], v209 offset:20992
    ds_read_b64_tr_b16 a[168:169], v210 offset:20832
    ds_read_b64_tr_b16 a[170:171], v210 offset:20992
    ds_read_b128 a[36:39], v205 offset:32768
    v_mfma_f32_32x32x16_bf16 v[134:149], a[204:207], a[28:31], v[134:149]
    ds_read_b64_tr_b16 a[172:173], v211 offset:20832
    ds_read_b64_tr_b16 a[174:175], v211 offset:20992
    ds_read_b64_tr_b16 a[176:177], v212 offset:20832
    v_mfma_f32_16x16x32_bf16 v[32:35], v[28:31], a[196:199], v[32:35]
    ds_read_b64_tr_b16 a[178:179], v212 offset:20992
    v_mfma_f32_16x16x32_bf16 v[36:39], v[28:31], a[200:203], v[36:39]
    ds_read_b64_tr_b16 a[180:181], v213 offset:20832
    v_mfma_f32_16x16x32_bf16 v[40:43], v[28:31], a[204:207], v[40:43]
    ds_read_b64_tr_b16 a[182:183], v213 offset:20992
    v_mfma_f32_4x4x4_16b_bf16 v[220:223], a[16:17], a[16:17], v[220:223]
    v_mfma_f32_4x4x4_16b_bf16 v[224:227], a[18:19], a[18:19], v[224:227]
    v_mfma_f32_4x4x4_16b_bf16 v[228:231], a[20:21], a[20:21], v[228:231]
    v_mfma_f32_4x4x4_16b_bf16 v[232:235], a[22:23], a[22:23], v[232:235]
    v_mfma_f32_4x4x4_16b_bf16 v[220:223], a[24:25], a[24:25], v[220:223]
    v_mfma_f32_4x4x4_16b_bf16 v[224:227], a[26:27], a[26:27], v[224:227]
    v_mfma_f32_4x4x4_16b_bf16 v[228:231], a[28:29], a[28:29], v[228:231]
    v_mfma_f32_4x4x4_16b_bf16 v[232:235], a[30:31], a[30:31], v[232:235]
    s_waitcnt lgkmcnt(0)
    v_mfma_f32_32x32x16_bf16 v[102:117], a[160:163], a[32:35], v[102:117]
    ds_read_b128 a[40:43], v206 offset:32768
    ds_read_b64_tr_b16 a[184:185], v214 offset:20832
    ds_read_b64_tr_b16 a[186:187], v214 offset:20992
    s_mul_i32 s61, s56, 192
    v_mfma_f32_32x32x16_bf16 v[118:133], a[164:167], a[32:35], v[118:133]
    ds_read_b64_tr_b16 a[188:189], v215 offset:20832
    s_add_u32 m0, s94, 16384
    ds_read_b64_tr_b16 a[190:191], v215 offset:20992
    buffer_load_dwordx4 v6, s[8:11], s84 offen offset:0 lds
    v_mfma_f32_32x32x16_bf16 v[134:149], a[168:171], a[32:35], v[134:149]
    ds_read_b64_tr_b16 a[192:193], v216 offset:20832
    ds_read_b64_tr_b16 a[194:195], v216 offset:20992
    buffer_load_dwordx4 v7, s[8:11], s84 offen offset:1024 lds
    v_mfma_f32_32x32x16_bf16 v[102:117], a[172:175], a[36:39], v[102:117]
    ds_read_b128 a[44:47], v207 offset:32768
    ds_read_b64_tr_b16 a[196:197], v217 offset:20832
    ds_read_b64_tr_b16 a[198:199], v217 offset:20992
    s_movk_i32 s63, 2880
    v_mfma_f32_32x32x16_bf16 v[118:133], a[176:179], a[36:39], v[118:133]
    ds_read_b64_tr_b16 a[200:201], v218 offset:20832
    ds_read_b64_tr_b16 a[202:203], v218 offset:20992
    buffer_load_dwordx4 v8, s[8:11], s84 offen offset:2048 lds
    v_mfma_f32_32x32x16_bf16 v[134:149], a[180:183], a[36:39], v[134:149]
    ds_read_b64_tr_b16 a[204:205], v219 offset:20832
    ds_read_b64_tr_b16 a[206:207], v219 offset:20992
    buffer_load_dwordx4 v9, s[8:11], s84 offen offset:3072 lds
    s_mul_i32 s84, s84, 1920
    s_waitcnt lgkmcnt(7)
    v_mfma_f32_32x32x16_bf16 v[102:117], a[184:187], a[40:43], v[102:117]
    s_add_u32 m0, s95, 41664
    s_nop 0
    buffer_load_dwordx4 v10, s[12:15], s84 offen offset:0 lds
    v_add_u32 v2, 0, v1
    v_mul_u32_u24 v3, 5462, v2
    v_lshrrev_b32 v3, 16, v3
    v_mfma_f32_32x32x16_bf16 v[118:133], a[188:191], a[40:43], v[118:133]
    buffer_load_dwordx4 v11, s[12:15], s84 offen offset:1024 lds
    v_mad_u32_u24 v2, v3, s63, v13
    v_add_u32 v46, s61, v2
    v_add_u32 v2, 64, v1
    v_mfma_f32_32x32x16_bf16 v[134:149], a[192:195], a[40:43], v[134:149]
    s_mov_b32 exec_hi, 0
    buffer_load_dwordx4 v12, s[12:15], s84 offen offset:2048 lds
    s_mov_b32 exec_hi, -1
    v_mul_u32_u24 v3, 5462, v2
    v_lshrrev_b32 v3, 16, v3
    v_mad_u32_u24 v2, v3, s63, v13
    v_add_u32 v47, s61, v2
    v_add_u32 v2, 128, v1
    v_mul_u32_u24 v3, 5462, v2
    v_lshrrev_b32 v3, 16, v3
    v_mad_u32_u24 v2, v3, s63, v13
    v_add_u32 v48, s61, v2
    s_and_b32 s59, s2, 6
    s_add_u32 s59, s59, s58
    s_lshl_b32 s59, s59, 2
    s_lshr_b32 s60, 911487504, s59
    s_and_b32 s60, s60, 7
    s_lshl_b32 s60, s60, 2
    s_add_u32 s60, s60, s52
    s_mul_i32 s72, s60, 49152
    s_lshr_b32 s60, 2232576, s59
    s_and_b32 s60, s60, 3
    s_lshl_b32 s60, s60, 2
    s_add_u32 s60, s60, s52
    s_mul_i32 s73, s60, 49152
    s_mul_i32 s61, s57, 160
    s_movk_i32 s63, 1120
    v_add_u32 v2, 0, v1
    v_mul_u32_u24 v3, 6554, v2
    v_lshrrev_b32 v3, 16, v3
    v_mad_u32_u24 v2, v3, s63, v13
    v_add_u32 v49, s61, v2
    v_add_u32 v2, 64, v1
    v_mul_u32_u24 v3, 6554, v2
    v_lshrrev_b32 v3, 16, v3
    v_mad_u32_u24 v2, v3, s63, v13
    v_add_u32 v50, s61, v2
    v_add_u32 v2, 128, v1
    v_mul_u32_u24 v3, 6554, v2
    v_lshrrev_b32 v3, 16, v3
    v_mad_u32_u24 v2, v3, s63, v13
    v_add_u32 v51, s61, v2
    v_bfe_u32 v2, v1, 2, 3
    v_or_b32 v2, 0x0c0c0c00, v2
    v_and_b32 v5, 3, v1
    v_mad_u32_u24 v5, v19, 24, v5
    s_mov_b32 s63, 0x5050404
    v_mov_b32 v4, 0x3010200
    v_perm_b32 v3, s63, v4, v2
    v_lshl_add_u32 v3, v3, 2, v5
    v_lshlrev_b32 v52, 4, v3
    v_lshlrev_b32 v53, 3, v3
    v_add_u32 v52, 159744, v52
    v_add_u32 v53, 161280, v53
    s_mov_b32 s63, 0x5050000
    v_mov_b32 v4, 0x4020301
    v_perm_b32 v3, s63, v4, v2
    v_lshl_add_u32 v3, v3, 2, v5
    v_lshlrev_b32 v54, 4, v3
    v_lshlrev_b32 v55, 3, v3
    v_add_u32 v54, 161664, v54
    v_add_u32 v55, 163200, v55
    v_bfe_u32 v2, v1, 4, 1
    v_and_b32 v23, 0xf0, v13
    v_lshl_add_u32 v23, v19, 8, v23
    v_mul_u32_u24 v2, 20480, v2
    s_waitcnt vmcnt(7) lgkmcnt(0)
    s_barrier
    v_mfma_f32_32x32x16_bf16 v[102:117], a[196:199], a[44:47], v[102:117]
    ds_read_b128 a[48:51], v204 offset:0
    ds_read_b64_tr_b16 a[160:161], v208 offset:31248
    ds_read_b64_tr_b16 a[162:163], v208 offset:31408
    ds_read_b64_tr_b16 a[164:165], v209 offset:31248
    v_mfma_f32_32x32x16_bf16 v[118:133], a[200:203], a[44:47], v[118:133]
    ds_read_b64_tr_b16 a[166:167], v209 offset:31408
    ds_read_b64_tr_b16 a[168:169], v210 offset:31248
    ds_read_b64_tr_b16 a[170:171], v210 offset:31408
    ds_read_b128 a[52:55], v205 offset:0
    v_mfma_f32_32x32x16_bf16 v[134:149], a[204:207], a[44:47], v[134:149]
    ds_read_b64_tr_b16 a[172:173], v211 offset:31248
    ds_read_b64_tr_b16 a[174:175], v211 offset:31408
    ds_read_b64_tr_b16 a[176:177], v212 offset:31248
    v_mfma_f32_16x16x32_bf16 v[32:35], v[28:31], a[196:199], v[32:35]
    ds_read_b64_tr_b16 a[178:179], v212 offset:31408
    v_mfma_f32_16x16x32_bf16 v[36:39], v[28:31], a[200:203], v[36:39]
    ds_read_b64_tr_b16 a[180:181], v213 offset:31248
    v_mfma_f32_16x16x32_bf16 v[40:43], v[28:31], a[204:207], v[40:43]
    ds_read_b64_tr_b16 a[182:183], v213 offset:31408
    v_mfma_f32_4x4x4_16b_bf16 v[220:223], a[32:33], a[32:33], v[220:223]
    v_mfma_f32_4x4x4_16b_bf16 v[224:227], a[34:35], a[34:35], v[224:227]
    v_mfma_f32_4x4x4_16b_bf16 v[228:231], a[36:37], a[36:37], v[228:231]
    v_mfma_f32_4x4x4_16b_bf16 v[232:235], a[38:39], a[38:39], v[232:235]
    v_mfma_f32_4x4x4_16b_bf16 v[220:223], a[40:41], a[40:41], v[220:223]
    v_mfma_f32_4x4x4_16b_bf16 v[224:227], a[42:43], a[42:43], v[224:227]
    v_mfma_f32_4x4x4_16b_bf16 v[228:231], a[44:45], a[44:45], v[228:231]
    v_mfma_f32_4x4x4_16b_bf16 v[232:235], a[46:47], a[46:47], v[232:235]
    s_waitcnt lgkmcnt(0)
    v_mfma_f32_32x32x16_bf16 v[102:117], a[160:163], a[48:51], v[102:117]
    ds_read_b128 a[56:59], v206 offset:0
    ds_read_b64_tr_b16 a[184:185], v214 offset:31248
    ds_read_b64_tr_b16 a[186:187], v214 offset:31408
    v_add_u32 v23, v2, v23
    v_mfma_f32_32x32x16_bf16 v[118:133], a[164:167], a[48:51], v[118:133]
    ds_read_b64_tr_b16 a[188:189], v215 offset:31248
    s_add_u32 m0, s94, 32768
    ds_read_b64_tr_b16 a[190:191], v215 offset:31408
    buffer_load_dwordx4 v6, s[8:11], s85 offen offset:0 lds
    v_mfma_f32_32x32x16_bf16 v[134:149], a[168:171], a[48:51], v[134:149]
    ds_read_b64_tr_b16 a[192:193], v216 offset:31248
    ds_read_b64_tr_b16 a[194:195], v216 offset:31408
    buffer_load_dwordx4 v7, s[8:11], s85 offen offset:1024 lds
    v_mfma_f32_32x32x16_bf16 v[102:117], a[172:175], a[52:55], v[102:117]
    ds_read_b128 a[60:63], v207 offset:0
    ds_read_b64_tr_b16 a[196:197], v217 offset:31248
    ds_read_b64_tr_b16 a[198:199], v217 offset:31408
    s_lshr_b32 s1, s57, 2
    v_mfma_f32_32x32x16_bf16 v[118:133], a[176:179], a[52:55], v[118:133]
    ds_read_b64_tr_b16 a[200:201], v218 offset:31248
    ds_read_b64_tr_b16 a[202:203], v218 offset:31408
    buffer_load_dwordx4 v8, s[8:11], s85 offen offset:2048 lds
    v_mfma_f32_32x32x16_bf16 v[134:149], a[180:183], a[52:55], v[134:149]
    ds_read_b64_tr_b16 a[204:205], v219 offset:31248
    ds_read_b64_tr_b16 a[206:207], v219 offset:31408
    buffer_load_dwordx4 v9, s[8:11], s85 offen offset:3072 lds
    s_mul_i32 s85, s85, 1920
    s_waitcnt lgkmcnt(7)
    v_mfma_f32_32x32x16_bf16 v[102:117], a[184:187], a[56:59], v[102:117]
    s_add_u32 m0, s95, 52080
    s_nop 0
    buffer_load_dwordx4 v10, s[12:15], s85 offen offset:0 lds
    s_lshl2_add_u32 s1, s1, s52
    s_and_b32 s59, s2, 7
    s_lshl3_add_u32 s1, s1, s59
    v_mfma_f32_32x32x16_bf16 v[118:133], a[188:191], a[56:59], v[118:133]
    buffer_load_dwordx4 v11, s[12:15], s85 offen offset:1024 lds
    s_lshl_b32 s1, s1, 7
    s_add_u32 s1, s1, 32832
    s_lshl_b32 s23, s54, 7
    v_mfma_f32_32x32x16_bf16 v[134:149], a[192:195], a[56:59], v[134:149]
    s_mov_b32 exec_hi, 0
    buffer_load_dwordx4 v12, s[12:15], s85 offen offset:2048 lds
    s_mov_b32 exec_hi, -1
    s_cmp_eq_u32 s52, 0
    s_cselect_b32 s23, s23, -16
    s_cselect_b32 s21, 16, 0
    s_cmp_lg_u32 s3, 0
    s_cbranch_scc1 L_et3
    s_mul_i32 s96, s64, 2688
    v_lshl_add_u32 v187, v1, 7, s96
    s_mov_b64 exec, 0x1fffff
    buffer_load_dword v14, v187, s[24:27], 0 offen
    s_mov_b64 exec, -1
    s_mul_i32 s96, s64, 13
    v_add_u32 v187, s96, v1
    v_mul_u32_u24 v188, 6554, v187
    v_lshrrev_b32 v188, 16, v188
    v_mul_u32_u24 v188, 2560, v188
    v_lshl_add_u32 v187, v187, 7, v188
    s_mov_b64 exec, 0x1fff
    buffer_load_dword v14, v187, s[12:15], 0 offen
    s_mov_b64 exec, -1
L_et3:
    s_mul_i32 s59, s64, 13108
    s_lshr_b32 s60, s59, 19
    s_bfe_u32 s59, s59, 0x10010
    s_lshr_b32 s61, s60, 1
    s_lshl2_add_u32 s61, s59, s61
    s_lshl2_add_u32 s59, s59, s60
    s_add_u32 s60, s61, 6
    s_cmp_lt_u32 s64, 160
    s_cselect_b32 s59, s59, s60
    s_lshl_b32 s59, s59, 10
    s_add_u32 s59, s59, 32704
    s_cmp_lt_u32 s64, 480
    s_cselect_b32 s59, s59, 0x7fff0000
    v_lshl_add_u32 v152, v1, 7, s59
    v_writelane_b32 v152, s23, 0
    s_mul_i32 s28, s54, 61440
    s_mul_i32 s60, s52, 960
    s_add_u32 s28, s28, s60
    s_add_u32 s28, s28, 1048576
    s_add_u32 s60, s60, 159744
    v_min_u32 v151, 944, v13
    v_add_u32 v150, s60, v13
    s_mul_i32 s20, s57, 68
    s_mul_i32 s60, s52, 5
    s_add_u32 s20, s20, s60
    s_mul_i32 s20, s20, 5120
    s_add_u32 s20, s20, 16777216
    s_lshl2_add_u32 s59, s53, s52
    s_mul_i32 s59, s59, 40960
    s_mul_i32 s60, s54, 1280
    s_add_u32 s59, s59, s60
    s_add_u32 s22, s59, 2097152
    v_and_b32 v2, 1, v1
    v_lshlrev_b32 v2, 4, v2
    s_movk_i32 s59, 0x3f80
    v_lshlrev_b32 v2, v2, s59
    s_mov_b32 s92, 0x3
    s_mov_b32 s93, 0x30
    v_cndmask_b32 v56, 0, v2, s[92:93]
    s_mov_b32 s92, 0xc
    s_mov_b32 s93, 0xc0
    v_cndmask_b32 v57, 0, v2, s[92:93]
    s_mov_b32 s92, 0x300
    s_mov_b32 s93, 0x3000
    v_cndmask_b32 v58, 0, v2, s[92:93]
    s_mov_b32 s92, 0xc00
    s_mov_b32 s93, 0xc000
    v_cndmask_b32 v59, 0, v2, s[92:93]
    v_mul_u32_u24 v2, 800, v19
    v_mad_u32_u24 v2, v20, 40, v2
    s_mov_b32 vcc_lo, 0x55555555
    s_mov_b32 vcc_hi, 0xaaaaaaaa
    s_mov_b32 s92, 0x22221111
    s_mov_b32 s93, 0x88884444
    v_bfe_u32 v70, v21, 1, 2
    v_lshlrev_b32 v70, 3, v70
    v_mov_b32 v5, 155200
    v_mul_i32_i24 v3, -160, v19
    v_add_u32 v3, 153760, v3
    v_add3_u32 v4, v2, v3, v70
    s_waitcnt vmcnt(7) lgkmcnt(0)
    s_barrier
    v_mfma_f32_32x32x16_bf16 v[102:117], a[196:199], a[60:63], v[102:117]
    ds_read_b128 a[64:67], v204 offset:16384
    ds_read_b64_tr_b16 a[160:161], v208 offset:41664
    ds_read_b64_tr_b16 a[162:163], v208 offset:41824
    ds_read_b64_tr_b16 a[164:165], v209 offset:41664
    v_mfma_f32_32x32x16_bf16 v[118:133], a[200:203], a[60:63], v[118:133]
    ds_read_b64_tr_b16 a[166:167], v209 offset:41824
    ds_read_b64_tr_b16 a[168:169], v210 offset:41664
    ds_read_b64_tr_b16 a[170:171], v210 offset:41824
    ds_read_b128 a[68:71], v205 offset:16384
    v_mfma_f32_32x32x16_bf16 v[134:149], a[204:207], a[60:63], v[134:149]
    ds_read_b64_tr_b16 a[172:173], v211 offset:41664
    ds_read_b64_tr_b16 a[174:175], v211 offset:41824
    ds_read_b64_tr_b16 a[176:177], v212 offset:41664
    v_mfma_f32_16x16x32_bf16 v[32:35], v[28:31], a[196:199], v[32:35]
    ds_read_b64_tr_b16 a[178:179], v212 offset:41824
    v_mfma_f32_16x16x32_bf16 v[36:39], v[28:31], a[200:203], v[36:39]
    ds_read_b64_tr_b16 a[180:181], v213 offset:41664
    v_mfma_f32_16x16x32_bf16 v[40:43], v[28:31], a[204:207], v[40:43]
    ds_read_b64_tr_b16 a[182:183], v213 offset:41824
    v_mfma_f32_4x4x4_16b_bf16 v[220:223], a[48:49], a[48:49], v[220:223]
    v_mfma_f32_4x4x4_16b_bf16 v[224:227], a[50:51], a[50:51], v[224:227]
    v_mfma_f32_4x4x4_16b_bf16 v[228:231], a[52:53], a[52:53], v[228:231]
    v_mfma_f32_4x4x4_16b_bf16 v[232:235], a[54:55], a[54:55], v[232:235]
    v_mfma_f32_4x4x4_16b_bf16 v[220:223], a[56:57], a[56:57], v[220:223]
    v_mfma_f32_4x4x4_16b_bf16 v[224:227], a[58:59], a[58:59], v[224:227]
    v_mfma_f32_4x4x4_16b_bf16 v[228:231], a[60:61], a[60:61], v[228:231]
    v_mfma_f32_4x4x4_16b_bf16 v[232:235], a[62:63], a[62:63], v[232:235]
    s_waitcnt lgkmcnt(0)
    v_mfma_f32_32x32x16_bf16 v[102:117], a[160:163], a[64:67], v[102:117]
    ds_read_b128 a[72:75], v206 offset:16384
    ds_read_b64_tr_b16 a[184:185], v214 offset:41664
    ds_read_b64_tr_b16 a[186:187], v214 offset:41824
    v_cndmask_b32 v4, v5, v4, vcc
    v_mfma_f32_32x32x16_bf16 v[118:133], a[164:167], a[64:67], v[118:133]
    ds_read_b64_tr_b16 a[188:189], v215 offset:41664
    ds_read_b64_tr_b16 a[190:191], v215 offset:41824
    buffer_load_dword v17, off, s[40:43], 0 sc1
    v_mfma_f32_32x32x16_bf16 v[134:149], a[168:171], a[64:67], v[134:149]
    ds_read_b64_tr_b16 a[192:193], v216 offset:41664
    s_add_u32 m0, s94, 0
    ds_read_b64_tr_b16 a[194:195], v216 offset:41824
    buffer_load_dwordx4 v6, s[8:11], s86 offen offset:0 lds
    v_mfma_f32_32x32x16_bf16 v[102:117], a[172:175], a[68:71], v[102:117]
    ds_read_b128 a[76:79], v207 offset:16384
    ds_read_b64_tr_b16 a[196:197], v217 offset:41664
    ds_read_b64_tr_b16 a[198:199], v217 offset:41824
    ds_read_b64_tr_b16 a[208:209], v4
    v_mfma_f32_32x32x16_bf16 v[118:133], a[176:179], a[68:71], v[118:133]
    ds_read_b64_tr_b16 a[200:201], v218 offset:41664
    ds_read_b64_tr_b16 a[202:203], v218 offset:41824
    buffer_load_dwordx4 v7, s[8:11], s86 offen offset:1024 lds
    v_mfma_f32_32x32x16_bf16 v[134:149], a[180:183], a[68:71], v[134:149]
    ds_read_b64_tr_b16 a[204:205], v219 offset:41664
    ds_read_b64_tr_b16 a[206:207], v219 offset:41824
    buffer_load_dwordx4 v8, s[8:11], s86 offen offset:2048 lds
    s_waitcnt lgkmcnt(8)
    v_mfma_f32_32x32x16_bf16 v[102:117], a[184:187], a[72:75], v[102:117]
    buffer_load_dwordx4 v9, s[8:11], s86 offen offset:3072 lds
    s_mul_i32 s86, s86, 1920
    v_add3_u32 v3, v2, v3, 32
    v_cndmask_b32 v4, v5, v3, s[92:93]
    ds_read_b64_tr_b16 a[220:221], v4
    v_mfma_f32_32x32x16_bf16 v[118:133], a[188:191], a[72:75], v[118:133]
    s_add_u32 m0, s95, 62496
    s_nop 0
    buffer_load_dwordx4 v10, s[12:15], s86 offen offset:0 lds
    v_mul_i32_i24 v3, -160, v19
    v_add_u32 v3, 153920, v3
    v_add3_u32 v4, v2, v3, v70
    v_mfma_f32_32x32x16_bf16 v[134:149], a[192:195], a[72:75], v[134:149]
    buffer_load_dwordx4 v11, s[12:15], s86 offen offset:1024 lds
    v_cndmask_b32 v4, v5, v4, vcc
    ds_read_b64_tr_b16 a[210:211], v4
    v_add3_u32 v3, v2, v3, 32
    s_mov_b32 exec_hi, 0
    buffer_load_dwordx4 v12, s[12:15], s86 offen offset:2048 lds
    s_mov_b32 exec_hi, -1
    s_cmp_lg_u32 s3, 1
    s_cbranch_scc1 L_et4
    s_mul_i32 s96, s64, 2688
    v_lshl_add_u32 v187, v1, 7, s96
    s_mov_b64 exec, 0x1fffff
    buffer_load_dword v14, v187, s[24:27], 0 offen
    s_mov_b64 exec, -1
    s_mul_i32 s96, s64, 13
    v_add_u32 v187, s96, v1
    v_mul_u32_u24 v188, 6554, v187
    v_lshrrev_b32 v188, 16, v188
    v_mul_u32_u24 v188, 2560, v188
    v_lshl_add_u32 v187, v187, 7, v188
    s_mov_b64 exec, 0x1fff
    buffer_load_dword v14, v187, s[12:15], 0 offen
    s_mov_b64 exec, -1
L_et4:
    v_cndmask_b32 v4, v5, v3, s[92:93]
    ds_read_b64_tr_b16 a[222:223], v4
    v_mul_i32_i24 v3, -160, v19
    v_add_u32 v3, 154080, v3
    v_add3_u32 v4, v2, v3, v70
    v_cndmask_b32 v4, v5, v4, vcc
    ds_read_b64_tr_b16 a[212:213], v4
    v_add3_u32 v3, v2, v3, 32
    v_cndmask_b32 v4, v5, v3, s[92:93]
    ds_read_b64_tr_b16 a[224:225], v4
    v_mul_i32_i24 v3, -160, v19
    v_add_u32 v3, 154240, v3
    v_add3_u32 v4, v2, v3, v70
    v_cndmask_b32 v4, v5, v4, vcc
    ds_read_b64_tr_b16 a[214:215], v4
    v_add3_u32 v3, v2, v3, 32
    v_cndmask_b32 v4, v5, v3, s[92:93]
    ds_read_b64_tr_b16 a[226:227], v4
    v_mul_i32_i24 v3, 640, v19
    v_add_u32 v3, 153600, v3
    v_add3_u32 v4, v2, v3, v70
    v_cndmask_b32 v4, v5, v4, vcc
    ds_read_b64_tr_b16 a[216:217], v4
    v_add3_u32 v3, v2, v3, 32
    v_cndmask_b32 v4, v5, v3, s[92:93]
    ds_read_b64_tr_b16 a[228:229], v4
    v_accvgpr_write_b32 a218, 0
    v_accvgpr_write_b32 a219, 0
    v_accvgpr_write_b32 a230, 0
    v_accvgpr_write_b32 a231, 0
    s_lshl2_add_u32 s59, s2, s52
    s_mul_i32 s60, s59, 640
    s_add_u32 s60, s60, 1376256
    v_lshl_add_u32 v184, v1, 7, s60
    v_mul_u32_u24 v182, 10923, v1
    v_lshrrev_b32 v182, 16, v182
    v_mul_u32_u24 v182, 5120, v182
    v_add_u32 v182, v182, v13
    s_add_u32 s59, s75, 0
    s_add_u32 s60, s74, 0
    s_mul_i32 s60, s60, 10240
L_pad0:
    s_cbranch_execz L_pad4
    s_add_u32 s61, s65, 0
    s_cmp_lt_u32 s64, 480
    s_cselect_b32 s29, s59, s61
    s_cselect_b32 s30, s60, s80
    s_add_u32 s59, s75, 1024
    s_add_u32 s60, s74, 1
    s_mul_i32 s60, s60, 10240
    s_add_u32 s61, s65, 5216
    s_cmp_lt_u32 s64, 480
    s_cselect_b32 s31, s59, s61
    s_cselect_b32 s39, s60, s81
    s_add_u32 s59, s75, 2048
    s_add_u32 s60, s74, 2
    s_mul_i32 s60, s60, 10240
    s_add_u32 s61, s65, 10432
    s_cmp_lt_u32 s64, 480
    s_cselect_b32 s79, s59, s61
    s_cselect_b32 s38, s60, s82
    s_cmp_lt_u32 s64, 480
    s_cselect_b64 s[4:5], s[4:5], s[12:13]
    s_cselect_b32 s6, s6, s14
    s_cselect_b64 vcc, -1, 0
    v_cndmask_b32 v253, v154, v253, vcc
    v_add_u32 v208, 52080, v208
    v_add_u32 v209, 52080, v209
    v_add_u32 v210, 52080, v210
    v_add_u32 v211, 52080, v211
    v_add_u32 v212, 52080, v212
    v_add_u32 v213, 52080, v213
    v_add_u32 v214, 52080, v214
    v_add_u32 v215, 52080, v215
    v_add_u32 v216, 52080, v216
    v_add_u32 v217, 52080, v217
    v_add_u32 v218, 52080, v218
    v_add_u32 v219, 52080, v219
    s_waitcnt vmcnt(8) lgkmcnt(0)
    s_barrier
    v_mfma_f32_32x32x16_bf16 v[102:117], a[196:199], a[76:79], v[102:117]
    ds_read_b128 a[80:83], v204 offset:32768
    ds_read_b64_tr_b16 a[160:161], v208 offset:0
    ds_read_b64_tr_b16 a[162:163], v208 offset:160
    ds_read_b64_tr_b16 a[164:165], v209 offset:0
    v_mfma_f32_32x32x16_bf16 v[118:133], a[200:203], a[76:79], v[118:133]
    ds_read_b64_tr_b16 a[166:167], v209 offset:160
    ds_read_b64_tr_b16 a[168:169], v210 offset:0
    ds_read_b64_tr_b16 a[170:171], v210 offset:160
    ds_read_b128 a[84:87], v205 offset:32768
    v_mfma_f32_32x32x16_bf16 v[134:149], a[204:207], a[76:79], v[134:149]
    ds_read_b64_tr_b16 a[172:173], v211 offset:0
    ds_read_b64_tr_b16 a[174:175], v211 offset:160
    ds_read_b64_tr_b16 a[176:177], v212 offset:0
    v_mfma_f32_16x16x32_bf16 v[32:35], v[28:31], a[196:199], v[32:35]
    ds_read_b64_tr_b16 a[178:179], v212 offset:160
    v_mfma_f32_16x16x32_bf16 v[36:39], v[28:31], a[200:203], v[36:39]
    ds_read_b64_tr_b16 a[180:181], v213 offset:0
    v_mfma_f32_16x16x32_bf16 v[40:43], v[28:31], a[204:207], v[40:43]
    ds_read_b64_tr_b16 a[182:183], v213 offset:160
    v_mfma_f32_4x4x4_16b_bf16 v[220:223], a[64:65], a[64:65], v[220:223]
    v_mfma_f32_4x4x4_16b_bf16 v[224:227], a[66:67], a[66:67], v[224:227]
    v_mfma_f32_4x4x4_16b_bf16 v[228:231], a[68:69], a[68:69], v[228:231]
    v_mfma_f32_4x4x4_16b_bf16 v[232:235], a[70:71], a[70:71], v[232:235]
    v_mfma_f32_4x4x4_16b_bf16 v[220:223], a[72:73], a[72:73], v[220:223]
    v_mfma_f32_4x4x4_16b_bf16 v[224:227], a[74:75], a[74:75], v[224:227]
    v_mfma_f32_4x4x4_16b_bf16 v[228:231], a[76:77], a[76:77], v[228:231]
    v_mfma_f32_4x4x4_16b_bf16 v[232:235], a[78:79], a[78:79], v[232:235]
    s_waitcnt lgkmcnt(0)
    v_mfma_f32_32x32x16_bf16 v[102:117], a[160:163], a[80:83], v[102:117]
    ds_read_b128 a[88:91], v206 offset:32768
    ds_read_b64_tr_b16 a[184:185], v214 offset:0
    ds_read_b64_tr_b16 a[186:187], v214 offset:160
    s_and_b32 s62, s2, 7
    v_mfma_f32_32x32x16_bf16 v[118:133], a[164:167], a[80:83], v[118:133]
    ds_read_b64_tr_b16 a[188:189], v215 offset:0
    s_add_u32 m0, s94, 16384
    ds_read_b64_tr_b16 a[190:191], v215 offset:160
    buffer_load_dwordx4 v6, s[8:11], s87 offen offset:0 lds
    v_mfma_f32_32x32x16_bf16 v[134:149], a[168:171], a[80:83], v[134:149]
    ds_read_b64_tr_b16 a[192:193], v216 offset:0
    ds_read_b64_tr_b16 a[194:195], v216 offset:160
    buffer_load_dwordx4 v7, s[8:11], s87 offen offset:1024 lds
    v_mfma_f32_32x32x16_bf16 v[102:117], a[172:175], a[84:87], v[102:117]
    ds_read_b128 a[92:95], v207 offset:32768
    ds_read_b64_tr_b16 a[196:197], v217 offset:0
    ds_read_b64_tr_b16 a[198:199], v217 offset:160
    s_lshl_b32 s62, s62, 2
    v_mfma_f32_32x32x16_bf16 v[118:133], a[176:179], a[84:87], v[118:133]
    ds_read_b64_tr_b16 a[200:201], v218 offset:0
    ds_read_b64_tr_b16 a[202:203], v218 offset:160
    buffer_load_dwordx4 v8, s[8:11], s87 offen offset:2048 lds
    v_mfma_f32_32x32x16_bf16 v[134:149], a[180:183], a[84:87], v[134:149]
    ds_read_b64_tr_b16 a[204:205], v219 offset:0
    ds_read_b64_tr_b16 a[206:207], v219 offset:160
    buffer_load_dwordx4 v9, s[8:11], s87 offen offset:3072 lds
    s_mul_i32 s87, s87, 1920
    s_waitcnt lgkmcnt(7)
    v_mfma_f32_32x32x16_bf16 v[102:117], a[184:187], a[88:91], v[102:117]
    s_add_u32 m0, s95, 72912
    s_nop 0
    buffer_load_dwordx4 v10, s[12:15], s87 offen offset:0 lds
    s_lshr_b32 s62, 0x42043210, s62
    s_and_b32 s62, s62, 7
    s_mul_i32 s62, s62, 5120
    v_mfma_f32_32x32x16_bf16 v[118:133], a[188:191], a[88:91], v[118:133]
    buffer_load_dwordx4 v11, s[12:15], s87 offen offset:1024 lds
    s_add_u32 s44, s20, s62
    s_add_u32 s62, s62, 5120
    s_sub_u32 s63, s62, 25600
    v_mfma_f32_32x32x16_bf16 v[134:149], a[192:195], a[88:91], v[134:149]
    s_mov_b32 exec_hi, 0
    buffer_load_dwordx4 v12, s[12:15], s87 offen offset:2048 lds
    s_mov_b32 exec_hi, -1
    s_min_u32 s62, s62, s63
    s_add_u32 s45, s20, s62
    s_add_u32 s62, s62, 5120
    s_cmp_lg_u32 s3, 2
    s_cbranch_scc1 L_et5
    s_mul_i32 s96, s64, 2688
    v_lshl_add_u32 v187, v1, 7, s96
    s_mov_b64 exec, 0x1fffff
    buffer_load_dword v14, v187, s[24:27], 0 offen
    s_mov_b64 exec, -1
    s_mul_i32 s96, s64, 13
    v_add_u32 v187, s96, v1
    v_mul_u32_u24 v188, 6554, v187
    v_lshrrev_b32 v188, 16, v188
    v_mul_u32_u24 v188, 2560, v188
    v_lshl_add_u32 v187, v187, 7, v188
    s_mov_b64 exec, 0x1fff
    buffer_load_dword v14, v187, s[12:15], 0 offen
    s_mov_b64 exec, -1
L_et5:
    s_sub_u32 s63, s62, 25600
    s_min_u32 s62, s62, s63
    s_add_u32 s46, s20, s62
    s_add_u32 s62, s62, 5120
    s_sub_u32 s63, s62, 25600
    s_min_u32 s62, s62, s63
    s_add_u32 s47, s20, s62
    s_add_u32 s62, s62, 5120
    s_sub_u32 s63, s62, 25600
    s_min_u32 s62, s62, s63
    s_add_u32 s48, s20, s62
    s_waitcnt vmcnt(7) lgkmcnt(0)
    s_barrier
    v_mfma_f32_32x32x16_bf16 v[102:117], a[196:199], a[92:95], v[102:117]
    ds_read_b128 a[96:99], v204 offset:0
    ds_read_b64_tr_b16 a[160:161], v208 offset:10416
    ds_read_b64_tr_b16 a[162:163], v208 offset:10576
    ds_read_b64_tr_b16 a[164:165], v209 offset:10416
    v_mfma_f32_32x32x16_bf16 v[118:133], a[200:203], a[92:95], v[118:133]
    ds_read_b64_tr_b16 a[166:167], v209 offset:10576
    ds_read_b64_tr_b16 a[168:169], v210 offset:10416
    ds_read_b64_tr_b16 a[170:171], v210 offset:10576
    ds_read_b128 a[100:103], v205 offset:0
    v_mfma_f32_32x32x16_bf16 v[134:149], a[204:207], a[92:95], v[134:149]
    ds_read_b64_tr_b16 a[172:173], v211 offset:10416
    ds_read_b64_tr_b16 a[174:175], v211 offset:10576
    ds_read_b64_tr_b16 a[176:177], v212 offset:10416
    v_mfma_f32_16x16x32_bf16 v[32:35], v[28:31], a[196:199], v[32:35]
    ds_read_b64_tr_b16 a[178:179], v212 offset:10576
    v_mfma_f32_16x16x32_bf16 v[36:39], v[28:31], a[200:203], v[36:39]
    ds_read_b64_tr_b16 a[180:181], v213 offset:10416
    v_mfma_f32_16x16x32_bf16 v[40:43], v[28:31], a[204:207], v[40:43]
    ds_read_b64_tr_b16 a[182:183], v213 offset:10576
    v_mfma_f32_4x4x4_16b_bf16 v[220:223], a[80:81], a[80:81], v[220:223]
    v_mfma_f32_4x4x4_16b_bf16 v[224:227], a[82:83], a[82:83], v[224:227]
    v_mfma_f32_4x4x4_16b_bf16 v[228:231], a[84:85], a[84:85], v[228:231]
    v_mfma_f32_4x4x4_16b_bf16 v[232:235], a[86:87], a[86:87], v[232:235]
    v_mfma_f32_4x4x4_16b_bf16 v[220:223], a[88:89], a[88:89], v[220:223]
    v_mfma_f32_4x4x4_16b_bf16 v[224:227], a[90:91], a[90:91], v[224:227]
    v_mfma_f32_4x4x4_16b_bf16 v[228:231], a[92:93], a[92:93], v[228:231]
    v_mfma_f32_4x4x4_16b_bf16 v[232:235], a[94:95], a[94:95], v[232:235]
    s_waitcnt lgkmcnt(0)
    v_mfma_f32_32x32x16_bf16 v[102:117], a[160:163], a[96:99], v[102:117]
    ds_read_b128 a[104:107], v206 offset:0
    ds_read_b64_tr_b16 a[184:185], v214 offset:10416
    ds_read_b64_tr_b16 a[186:187], v214 offset:10576
    v_mfma_f32_32x32x16_bf16 v[118:133], a[164:167], a[96:99], v[118:133]
    ds_read_b64_tr_b16 a[188:189], v215 offset:10416
    s_add_u32 m0, s94, 32768
    ds_read_b64_tr_b16 a[190:191], v215 offset:10576
    buffer_load_dwordx4 v6, s[8:11], s88 offen offset:0 lds
    v_mfma_f32_32x32x16_bf16 v[134:149], a[168:171], a[96:99], v[134:149]
    ds_read_b64_tr_b16 a[192:193], v216 offset:10416
    ds_read_b64_tr_b16 a[194:195], v216 offset:10576
    buffer_load_dwordx4 v7, s[8:11], s88 offen offset:1024 lds
    v_mfma_f32_32x32x16_bf16 v[102:117], a[172:175], a[100:103], v[102:117]
    ds_read_b128 a[108:111], v207 offset:0
    ds_read_b64_tr_b16 a[196:197], v217 offset:10416
    ds_read_b64_tr_b16 a[198:199], v217 offset:10576
    v_mfma_f32_32x32x16_bf16 v[118:133], a[176:179], a[100:103], v[118:133]
    ds_read_b64_tr_b16 a[200:201], v218 offset:10416
    ds_read_b64_tr_b16 a[202:203], v218 offset:10576
    buffer_load_dwordx4 v8, s[8:11], s88 offen offset:2048 lds
    v_mfma_f32_32x32x16_bf16 v[134:149], a[180:183], a[100:103], v[134:149]
    ds_read_b64_tr_b16 a[204:205], v219 offset:10416
    ds_read_b64_tr_b16 a[206:207], v219 offset:10576
    buffer_load_dwordx4 v9, s[8:11], s88 offen offset:3072 lds
    s_mul_i32 s88, s88, 1920
    s_waitcnt lgkmcnt(7)
    v_mfma_f32_32x32x16_bf16 v[102:117], a[184:187], a[104:107], v[102:117]
    s_add_u32 m0, s95, 83328
    s_nop 0
    buffer_load_dwordx4 v10, s[12:15], s88 offen offset:0 lds
    v_mfma_f32_32x32x16_bf16 v[118:133], a[188:191], a[104:107], v[118:133]
    buffer_load_dwordx4 v11, s[12:15], s88 offen offset:1024 lds
    v_mfma_f32_32x32x16_bf16 v[134:149], a[192:195], a[104:107], v[134:149]
    s_mov_b32 exec_hi, 0
    buffer_load_dwordx4 v12, s[12:15], s88 offen offset:2048 lds
    s_mov_b32 exec_hi, -1
    v_readfirstlane_b32 s97, v17
    s_nop 1
    s_cmp_ge_u32 s97, 16
    s_cbranch_scc1 L_pout7
    s_mov_b32 s3, 0
L_poll6:
    buffer_load_dword v17, off, s[40:43], 0 sc1
    s_add_u32 s3, s3, 1
    s_waitcnt vmcnt(0)
    s_cmp_gt_u32 s3, 0x40000
    s_cbranch_scc1 L_pout7
    v_readfirstlane_b32 s97, v17
    s_nop 1
    s_cmp_lt_u32 s97, 16
    s_cbranch_scc1 L_poll6
L_pout7:
    s_waitcnt vmcnt(7) lgkmcnt(0)
    s_barrier
    v_mfma_f32_32x32x16_bf16 v[102:117], a[196:199], a[108:111], v[102:117]
    ds_read_b128 a[112:115], v204 offset:16384
    ds_read_b64_tr_b16 a[160:161], v208 offset:20832
    ds_read_b64_tr_b16 a[162:163], v208 offset:20992
    ds_read_b64_tr_b16 a[164:165], v209 offset:20832
    v_mfma_f32_32x32x16_bf16 v[118:133], a[200:203], a[108:111], v[118:133]
    ds_read_b64_tr_b16 a[166:167], v209 offset:20992
    ds_read_b64_tr_b16 a[168:169], v210 offset:20832
    ds_read_b64_tr_b16 a[170:171], v210 offset:20992
    ds_read_b128 a[116:119], v205 offset:16384
    v_mfma_f32_32x32x16_bf16 v[134:149], a[204:207], a[108:111], v[134:149]
    ds_read_b64_tr_b16 a[172:173], v211 offset:20832
    ds_read_b64_tr_b16 a[174:175], v211 offset:20992
    ds_read_b64_tr_b16 a[176:177], v212 offset:20832
    v_mfma_f32_16x16x32_bf16 v[32:35], v[28:31], a[196:199], v[32:35]
    ds_read_b64_tr_b16 a[178:179], v212 offset:20992
    v_mfma_f32_16x16x32_bf16 v[36:39], v[28:31], a[200:203], v[36:39]
    ds_read_b64_tr_b16 a[180:181], v213 offset:20832
    v_mfma_f32_16x16x32_bf16 v[40:43], v[28:31], a[204:207], v[40:43]
    ds_read_b64_tr_b16 a[182:183], v213 offset:20992
    v_mfma_f32_4x4x4_16b_bf16 v[220:223], a[96:97], a[96:97], v[220:223]
    v_mfma_f32_4x4x4_16b_bf16 v[224:227], a[98:99], a[98:99], v[224:227]
    v_mfma_f32_4x4x4_16b_bf16 v[228:231], a[100:101], a[100:101], v[228:231]
    v_mfma_f32_4x4x4_16b_bf16 v[232:235], a[102:103], a[102:103], v[232:235]
    v_mfma_f32_4x4x4_16b_bf16 v[220:223], a[104:105], a[104:105], v[220:223]
    v_mfma_f32_4x4x4_16b_bf16 v[224:227], a[106:107], a[106:107], v[224:227]
    v_mfma_f32_4x4x4_16b_bf16 v[228:231], a[108:109], a[108:109], v[228:231]
    v_mfma_f32_4x4x4_16b_bf16 v[232:235], a[110:111], a[110:111], v[232:235]
    s_waitcnt lgkmcnt(0)
    v_mfma_f32_32x32x16_bf16 v[102:117], a[160:163], a[112:115], v[102:117]
    ds_read_b128 a[120:123], v206 offset:16384
    ds_read_b64_tr_b16 a[184:185], v214 offset:20832
    ds_read_b64_tr_b16 a[186:187], v214 offset:20992
    v_mfma_f32_32x32x16_bf16 v[118:133], a[164:167], a[112:115], v[118:133]
    ds_read_b64_tr_b16 a[188:189], v215 offset:20832
    s_add_u32 m0, s94, 0
    ds_read_b64_tr_b16 a[190:191], v215 offset:20992
    buffer_load_dwordx4 v6, s[8:11], s89 offen offset:0 lds
    v_mfma_f32_32x32x16_bf16 v[134:149], a[168:171], a[112:115], v[134:149]
    ds_read_b64_tr_b16 a[192:193], v216 offset:20832
    ds_read_b64_tr_b16 a[194:195], v216 offset:20992
    buffer_load_dwordx4 v7, s[8:11], s89 offen offset:1024 lds
    s_mov_b32 exec_hi, 0xfffffff
    ds_write_b128 v182, v[200:203] offset:5120
    s_mov_b32 exec_hi, -1
    v_mfma_f32_32x32x16_bf16 v[102:117], a[172:175], a[116:119], v[102:117]
    ds_read_b128 a[124:127], v207 offset:16384
    ds_read_b64_tr_b16 a[196:197], v217 offset:20832
    ds_read_b64_tr_b16 a[198:199], v217 offset:20992
    v_mfma_f32_32x32x16_bf16 v[118:133], a[176:179], a[116:119], v[118:133]
    ds_read_b64_tr_b16 a[200:201], v218 offset:20832
    ds_read_b64_tr_b16 a[202:203], v218 offset:20992
    buffer_load_dwordx4 v8, s[8:11], s89 offen offset:2048 lds
    v_mfma_f32_32x32x16_bf16 v[134:149], a[180:183], a[116:119], v[134:149]
    ds_read_b64_tr_b16 a[204:205], v219 offset:20832
    ds_read_b64_tr_b16 a[206:207], v219 offset:20992
    buffer_load_dwordx4 v9, s[8:11], s89 offen offset:3072 lds
    s_mul_i32 s89, s89, 1920
    s_waitcnt lgkmcnt(8)
    v_mfma_f32_32x32x16_bf16 v[102:117], a[184:187], a[120:123], v[102:117]
    s_add_u32 m0, s95, 93744
    s_nop 0
    buffer_load_dwordx4 v10, s[12:15], s89 offen offset:0 lds
    v_mfma_f32_32x32x16_bf16 v[118:133], a[188:191], a[120:123], v[118:133]
    buffer_load_dwordx4 v11, s[12:15], s89 offen offset:1024 lds
    v_mfma_f32_32x32x16_bf16 v[134:149], a[192:195], a[120:123], v[134:149]
    s_mov_b32 exec_hi, 0
    buffer_load_dwordx4 v12, s[12:15], s89 offen offset:2048 lds
    s_mov_b32 exec_hi, -1
    s_waitcnt vmcnt(7) lgkmcnt(0)
    s_barrier
    v_mfma_f32_32x32x16_bf16 v[102:117], a[196:199], a[124:127], v[102:117]
    ds_read_b128 a[128:131], v204 offset:32768
    ds_read_b64_tr_b16 a[160:161], v208 offset:31248
    ds_read_b64_tr_b16 a[162:163], v208 offset:31408
    ds_read_b64_tr_b16 a[164:165], v209 offset:31248
    v_mfma_f32_32x32x16_bf16 v[118:133], a[200:203], a[124:127], v[118:133]
    ds_read_b64_tr_b16 a[166:167], v209 offset:31408
    ds_read_b64_tr_b16 a[168:169], v210 offset:31248
    ds_read_b64_tr_b16 a[170:171], v210 offset:31408
    ds_read_b128 a[132:135], v205 offset:32768
    v_mfma_f32_32x32x16_bf16 v[134:149], a[204:207], a[124:127], v[134:149]
    ds_read_b64_tr_b16 a[172:173], v211 offset:31248
    ds_read_b64_tr_b16 a[174:175], v211 offset:31408
    ds_read_b64_tr_b16 a[176:177], v212 offset:31248
    v_mfma_f32_16x16x32_bf16 v[32:35], v[28:31], a[196:199], v[32:35]
    ds_read_b64_tr_b16 a[178:179], v212 offset:31408
    v_mfma_f32_16x16x32_bf16 v[36:39], v[28:31], a[200:203], v[36:39]
    ds_read_b64_tr_b16 a[180:181], v213 offset:31248
    v_mfma_f32_16x16x32_bf16 v[40:43], v[28:31], a[204:207], v[40:43]
    ds_read_b64_tr_b16 a[182:183], v213 offset:31408
    v_mfma_f32_4x4x4_16b_bf16 v[220:223], a[112:113], a[112:113], v[220:223]
    v_mfma_f32_4x4x4_16b_bf16 v[224:227], a[114:115], a[114:115], v[224:227]
    v_mfma_f32_4x4x4_16b_bf16 v[228:231], a[116:117], a[116:117], v[228:231]
    v_mfma_f32_4x4x4_16b_bf16 v[232:235], a[118:119], a[118:119], v[232:235]
    v_mfma_f32_4x4x4_16b_bf16 v[220:223], a[120:121], a[120:121], v[220:223]
    v_mfma_f32_4x4x4_16b_bf16 v[224:227], a[122:123], a[122:123], v[224:227]
    v_mfma_f32_4x4x4_16b_bf16 v[228:231], a[124:125], a[124:125], v[228:231]
    v_mfma_f32_4x4x4_16b_bf16 v[232:235], a[126:127], a[126:127], v[232:235]
    s_waitcnt lgkmcnt(0)
    v_mfma_f32_32x32x16_bf16 v[102:117], a[160:163], a[128:131], v[102:117]
    ds_read_b128 a[136:139], v206 offset:32768
    ds_read_b64_tr_b16 a[184:185], v214 offset:31248
    ds_read_b64_tr_b16 a[186:187], v214 offset:31408
    v_mfma_f32_32x32x16_bf16 v[118:133], a[164:167], a[128:131], v[118:133]
    ds_read_b64_tr_b16 a[188:189], v215 offset:31248
    ds_read_b64_tr_b16 a[190:191], v215 offset:31408
    s_mov_b64 exec, 31
    buffer_load_dword v14, v184, s[24:27], 0 offen
    s_mov_b64 exec, -1
    v_mfma_f32_32x32x16_bf16 v[134:149], a[168:171], a[128:131], v[134:149]
    ds_read_b64_tr_b16 a[192:193], v216 offset:31248
    s_mov_b32 m0, s29
    ds_read_b64_tr_b16 a[194:195], v216 offset:31408
    buffer_load_dwordx4 v253, s[4:7], s30 offen lds
    v_mfma_f32_32x32x16_bf16 v[102:117], a[172:175], a[132:135], v[102:117]
    ds_read_b128 a[140:143], v207 offset:32768
    ds_read_b64_tr_b16 a[196:197], v217 offset:31248
    ds_read_b64_tr_b16 a[198:199], v217 offset:31408
    v_mfma_f32_32x32x16_bf16 v[118:133], a[176:179], a[132:135], v[118:133]
    ds_read_b64_tr_b16 a[200:201], v218 offset:31248
    ds_read_b64_tr_b16 a[202:203], v218 offset:31408
    v_mfma_f32_32x32x16_bf16 v[134:149], a[180:183], a[132:135], v[134:149]
    ds_read_b64_tr_b16 a[204:205], v219 offset:31248
    s_mov_b32 m0, s31
    ds_read_b64_tr_b16 a[206:207], v219 offset:31408
    buffer_load_dwordx4 v253, s[4:7], s39 offen lds
    s_waitcnt lgkmcnt(7)
    v_mfma_f32_32x32x16_bf16 v[102:117], a[184:187], a[136:139], v[102:117]
    v_mfma_f32_32x32x16_bf16 v[118:133], a[188:191], a[136:139], v[118:133]
    s_mov_b32 m0, s79
    s_nop 0
    buffer_load_dwordx4 v253, s[4:7], s38 offen lds
    v_mfma_f32_32x32x16_bf16 v[134:149], a[192:195], a[136:139], v[134:149]
    s_waitcnt vmcnt(7)
    s_waitcnt lgkmcnt(4)
    v_mfma_f32_32x32x16_bf16 v[102:117], a[196:199], a[140:143], v[102:117]
    ds_read_b128 a[144:147], v204 offset:0
    ds_read_b128 a[148:151], v205 offset:0
    ds_read_b128 a[152:155], v206 offset:0
    ds_read_b128 a[156:159], v207 offset:0
    s_waitcnt lgkmcnt(6)
    v_mfma_f32_32x32x16_bf16 v[118:133], a[200:203], a[140:143], v[118:133]
    s_mov_b32 vcc_lo, 0xaaaaaaaa
    s_mov_b32 vcc_hi, 0xaaaaaaaa
    s_mov_b32 s92, 0xcccccccc
    s_mov_b32 s93, 0xcccccccc
    v_mfma_f32_4x4x4_16b_bf16 v[220:223], a[128:129], a[128:129], v[220:223]
    v_mfma_f32_4x4x4_16b_bf16 v[224:227], a[130:131], a[130:131], v[224:227]
    v_mfma_f32_4x4x4_16b_bf16 v[228:231], a[132:133], a[132:133], v[228:231]
    v_mfma_f32_4x4x4_16b_bf16 v[232:235], a[134:135], a[134:135], v[232:235]
    v_mfma_f32_4x4x4_16b_bf16 v[220:223], a[136:137], a[136:137], v[220:223]
    v_mfma_f32_4x4x4_16b_bf16 v[224:227], a[138:139], a[138:139], v[224:227]
    v_mfma_f32_4x4x4_16b_bf16 v[228:231], a[140:141], a[140:141], v[228:231]
    v_mfma_f32_4x4x4_16b_bf16 v[232:235], a[142:143], a[142:143], v[232:235]
    s_waitcnt lgkmcnt(3)
    v_mfma_f32_4x4x4_16b_bf16 v[220:223], a[144:145], a[144:145], v[220:223]
    v_mfma_f32_4x4x4_16b_bf16 v[224:227], a[146:147], a[146:147], v[224:227]
    s_waitcnt lgkmcnt(2)
    v_mfma_f32_4x4x4_16b_bf16 v[228:231], a[148:149], a[148:149], v[228:231]
    v_mfma_f32_4x4x4_16b_bf16 v[232:235], a[150:151], a[150:151], v[232:235]
    s_waitcnt lgkmcnt(1)
    v_mfma_f32_4x4x4_16b_bf16 v[220:223], a[152:153], a[152:153], v[220:223]
    v_mfma_f32_4x4x4_16b_bf16 v[224:227], a[154:155], a[154:155], v[224:227]
    s_waitcnt lgkmcnt(0)
    v_mfma_f32_4x4x4_16b_bf16 v[228:231], a[156:157], a[156:157], v[228:231]
    v_mfma_f32_4x4x4_16b_bf16 v[232:235], a[158:159], a[158:159], v[232:235]
    v_mfma_f32_16x16x32_bf16 v[32:35], v[28:31], a[196:199], v[32:35]
    v_mfma_f32_16x16x32_bf16 v[36:39], v[28:31], a[200:203], v[36:39]
    v_mfma_f32_16x16x32_bf16 v[40:43], v[28:31], a[204:207], v[40:43]
    v_mfma_f32_32x32x16_bf16 v[134:149], a[204:207], a[140:143], v[134:149]
    v_add_f32 v220, v220, v224
    v_add_f32 v228, v228, v232
    v_add_f32 v221, v221, v225
    v_add_f32 v229, v229, v233
    v_add_f32 v222, v222, v226
    v_add_f32 v230, v230, v234
    v_add_f32 v223, v223, v227
    v_add_f32 v231, v231, v235
    v_add_f32 v220, v220, v228
    v_add_f32 v221, v221, v229
    v_add_f32 v222, v222, v230
    v_add_f32 v223, v223, v231
    v_cndmask_b32 v220, v220, v221, vcc
    v_cndmask_b32 v222, v222, v223, vcc
    v_cndmask_b32 v220, v220, v222, s[92:93]
    v_mov_b32 v221, v220
    s_nop 1
    v_permlane32_swap_b32 v220, v221
    s_cmp_ge_u32 s64, 480
    s_cbranch_scc1 L_nr8
    s_add_u32 m0, s75, 3072
    s_add_u32 s96, s74, 3
    s_mul_i32 s96, s96, 10240
    buffer_load_dwordx4 v253, s[4:7], s96 offen lds
    s_add_u32 m0, s75, 4096
    s_add_u32 s96, s74, 4
    s_mul_i32 s96, s96, 10240
    buffer_load_dwordx4 v253, s[4:7], s96 offen lds
    s_add_u32 m0, s75, 5120
    s_mul_i32 s96, s76, 10240
    buffer_load_dwordx4 v253, s[4:7], s96 offen lds
    s_waitcnt vmcnt(7)
    s_branch L_nr8x
L_nr8:
    s_waitcnt vmcnt(4)
L_nr8x:
    s_barrier
    ds_read_b64_tr_b16 a[160:161], v208 offset:41664
    ds_read_b64_tr_b16 a[162:163], v208 offset:41824
    ds_read_b64_tr_b16 a[164:165], v209 offset:41664
    ds_read_b64_tr_b16 a[166:167], v209 offset:41824
    ds_read_b64_tr_b16 a[168:169], v210 offset:41664
    ds_read_b64_tr_b16 a[170:171], v210 offset:41824
    ds_read_b64_tr_b16 a[180:181], v213 offset:41664
    ds_read_b64_tr_b16 a[182:183], v213 offset:41824
    ds_read_b64_tr_b16 a[192:193], v216 offset:41664
    ds_read_b64_tr_b16 a[194:195], v216 offset:41824
    ds_read_b64_tr_b16 a[204:205], v219 offset:41664
    ds_read_b64_tr_b16 a[206:207], v219 offset:41824
    s_waitcnt lgkmcnt(10)
    v_mfma_f32_16x16x32_bf16 v[32:35], v[28:31], a[160:163], v[32:35]
    ds_read_b64_tr_b16 a[172:173], v211 offset:41664
    s_waitcnt lgkmcnt(9)
    v_mfma_f32_16x16x32_bf16 v[36:39], v[28:31], a[164:167], v[36:39]
    ds_read_b64_tr_b16 a[174:175], v211 offset:41824
    s_waitcnt lgkmcnt(8)
    v_mfma_f32_16x16x32_bf16 v[40:43], v[28:31], a[168:171], v[40:43]
    ds_read_b64_tr_b16 a[176:177], v212 offset:41664
    v_mfma_f32_32x32x16_bf16 v[134:149], a[168:171], a[144:147], v[134:149]
    ds_read_b64_tr_b16 a[178:179], v212 offset:41824
    ds_read_b64_tr_b16 a[184:185], v214 offset:41664
    ds_read_b64_tr_b16 a[186:187], v214 offset:41824
    ds_read_b64_tr_b16 a[188:189], v215 offset:41664
    s_waitcnt lgkmcnt(11)
    v_mfma_f32_32x32x16_bf16 v[134:149], a[180:183], a[148:151], v[134:149]
    v_mov_b32 v33, v36
    v_mov_b32 v34, v40
    ds_write_b128 v44, v[32:35]
    ds_read_b64_tr_b16 a[190:191], v215 offset:41824
    s_waitcnt lgkmcnt(11)
    v_mfma_f32_32x32x16_bf16 v[134:149], a[192:195], a[152:155], v[134:149]
    ds_read_b64_tr_b16 a[196:197], v217 offset:41664
    ds_read_b64_tr_b16 a[198:199], v217 offset:41824
    ds_read_b64_tr_b16 a[200:201], v218 offset:41664
    ds_read_b64_tr_b16 a[202:203], v218 offset:41824
    s_waitcnt lgkmcnt(13)
    v_mfma_f32_32x32x16_bf16 v[134:149], a[204:207], a[156:159], v[134:149]
    v_mfma_f32_32x32x16_bf16 v[102:117], a[160:163], a[144:147], v[102:117]
    s_waitcnt lgkmcnt(0)
    s_barrier
    ds_read_b128 v[182:185], v45 offset:0
    ds_read_b128 v[186:189], v45 offset:1024
    ds_read_b128 v[190:193], v45 offset:2048
    ds_read_b128 v[194:197], v45 offset:3072
    v_mfma_f32_32x32x16_bf16 v[118:133], a[164:167], a[144:147], v[118:133]
    v_add_f32 v220, v220, v221
    v_mul_f32 v220, 0x3acccccd, v220
    s_nop 1
    v_mul_f32 v224, 0xbacccccd, v142
    v_cvt_pk_bf16_f32 v24, v224, v224
    v_and_b32 v225, 0xffff0000, v24
    v_mfma_f32_32x32x16_bf16 v[102:117], a[172:175], a[148:151], v[102:117]
    v_fma_f32 v220, -v224, v224, v220
    v_sub_f32 v225, v224, v225
    v_max_f32 v220, 0, v220
    v_cvt_pk_bf16_f32 v25, v225, 0
    v_cndmask_b32 v24, 0, v24, s[90:91]
    v_mfma_f32_32x32x16_bf16 v[118:133], a[176:179], a[148:151], v[118:133]
    v_cndmask_b32 v25, 0, v25, s[90:91]
    s_waitcnt lgkmcnt(2)
    v_add_f32 v182, v182, v186
    v_add_f32 v183, v183, v187
    v_add_f32 v184, v184, v188
    s_waitcnt lgkmcnt(0)
    v_add_f32 v190, v190, v194
    v_mfma_f32_32x32x16_bf16 v[102:117], a[184:187], a[152:155], v[102:117]
    v_add_f32 v191, v191, v195
    v_add_f32 v192, v192, v196
    v_add_f32 v182, v182, v190
    v_add_f32 v183, v183, v191
    v_add_f32 v184, v184, v192
    v_mfma_f32_32x32x16_bf16 v[118:133], a[188:191], a[152:155], v[118:133]
    v_cvt_pk_bf16_f32 v61, v182, 0
    v_lshlrev_b32 v187, 16, v61
    v_sub_f32 v188, v182, v187
    v_cvt_pk_bf16_f32 v60, v187, v188
    v_cvt_pk_bf16_f32 v63, v183, 0
    v_mfma_f32_32x32x16_bf16 v[102:117], a[196:199], a[156:159], v[102:117]
    v_lshlrev_b32 v187, 16, v63
    v_sub_f32 v188, v183, v187
    v_cvt_pk_bf16_f32 v62, v187, v188
    v_cvt_pk_bf16_f32 v65, v184, 0
    v_lshlrev_b32 v187, 16, v65
    v_mfma_f32_32x32x16_bf16 v[118:133], a[200:203], a[156:159], v[118:133]
    v_sub_f32 v188, v184, v187
    v_cvt_pk_bf16_f32 v64, v187, v188
    s_cmp_ge_u32 s64, 480
    s_cbranch_scc1 L_nr9
    s_add_u32 m0, s65, 0
    s_nop 0
    buffer_load_dwordx4 v154, s[12:15], s80 offen lds
    s_add_u32 m0, s65, 5216
    s_nop 0
    buffer_load_dwordx4 v154, s[12:15], s81 offen lds
    s_add_u32 m0, s65, 10432
    s_nop 0
    buffer_load_dwordx4 v154, s[12:15], s82 offen lds
L_nr9:
    s_add_u32 m0, s65, 15648
    s_nop 0
    buffer_load_dwordx4 v154, s[12:15], s83 offen lds
    v_mfma_f32_32x32x16_bf16 v[102:117], v[60:63], v[24:27], v[102:117]
    v_add_f32 v220, 0x3727c5ac, v220
    v_rsq_f32 v69, v220
    v_mfma_f32_32x32x16_bf16 v[118:133], v[62:65], v[24:27], v[118:133]
    v_mul_f32 v68, 0x3fb8aa3b, v69
    v_mfma_f32_32x32x16_bf16 v[134:149], v[64:67], v[24:27], v[134:149]
    s_nop 6
    v_cvt_pk_bf16_f32 v90, v102, v103
    v_cvt_pk_bf16_f32 v91, v104, v105
    v_cvt_pk_bf16_f32 v92, v106, v107
    v_cvt_pk_bf16_f32 v93, v108, v109
    v_cvt_pk_bf16_f32 v94, v110, v111
    v_cvt_pk_bf16_f32 v95, v112, v113
    v_cvt_pk_bf16_f32 v96, v114, v115
    v_cvt_pk_bf16_f32 v97, v116, v117
    v_cvt_pk_bf16_f32 v98, v118, v119
    v_cvt_pk_bf16_f32 v99, v120, v121
    v_mfma_f32_32x32x16_bf16 v[198:213], a[208:211], v[90:93], 0
    v_mul_f32 v122, v69, v122
    v_mul_f32 v123, v69, v123
    v_cvt_pk_bf16_f32 v164, v122, v123
    v_mul_f32 v124, v69, v124
    v_mul_f32 v125, v69, v125
    v_cvt_pk_bf16_f32 v165, v124, v125
    v_mfma_f32_32x32x16_bf16 v[198:213], a[212:215], v[94:97], v[198:213]
    v_mul_f32 v126, v69, v126
    v_mul_f32 v127, v69, v127
    v_cvt_pk_bf16_f32 v166, v126, v127
    v_mul_f32 v128, v69, v128
    v_mul_f32 v129, v69, v129
    v_cvt_pk_bf16_f32 v167, v128, v129
    v_mfma_f32_32x32x16_bf16 v[198:213], a[216:219], v[98:101], v[198:213]
    s_add_u32 m0, s66, 4096
    s_nop 0
    buffer_load_dwordx4 v155, s[12:15], s67 offen lds
    ds_write_b128 v176, v[164:167] offset:0
    v_mul_f32 v130, v69, v130
    v_mul_f32 v131, v69, v131
    v_cvt_pk_bf16_f32 v168, v130, v131
    v_mul_f32 v132, v69, v132
    v_mul_f32 v133, v69, v133
    v_mfma_f32_16x16x32_bf16 v[214:217], a[220:223], v[90:93], 0
    v_cvt_pk_bf16_f32 v169, v132, v133
    v_mul_f32 v134, v69, v134
    v_mfma_f32_16x16x32_bf16 v[214:217], a[224:227], v[94:97], v[214:217]
    v_mul_f32 v135, v69, v135
    v_cvt_pk_bf16_f32 v170, v134, v135
    v_mfma_f32_16x16x32_bf16 v[214:217], a[228:231], v[98:101], v[214:217]
    v_mul_f32 v136, v69, v136
    v_mul_f32 v137, v69, v137
    v_cvt_pk_bf16_f32 v171, v136, v137
    ds_write_b128 v176, v[168:171] offset:16
    v_mul_f32 v138, v69, v138
    v_mul_f32 v139, v69, v139
    v_cvt_pk_bf16_f32 v172, v138, v139
    v_mul_f32 v140, v69, v140
    v_mul_f32 v141, v69, v141
    v_cvt_pk_bf16_f32 v173, v140, v141
    ds_write_b128 v176, v[172:175] offset:32
    v_max3_f32 v6, v198, v199, v200
    s_add_u32 m0, s65, 20864
L_pad1:
    s_cbranch_execz L_pad5
    v_min3_f32 v7, v198, v199, v200
    buffer_load_dwordx4 v154, s[12:15], s84 offen lds
    v_max3_f32 v6, v6, v201, v202
    v_min3_f32 v7, v7, v201, v202
    v_max3_f32 v6, v6, v203, v204
    v_min3_f32 v7, v7, v203, v204
    v_max3_f32 v6, v6, v205, v206
    v_min3_f32 v7, v7, v205, v206
    v_max3_f32 v6, v6, v207, v208
    v_min3_f32 v7, v7, v207, v208
    v_max3_f32 v6, v6, v209, v210
    v_min3_f32 v7, v7, v209, v210
    v_max3_f32 v6, v6, v211, v212
    v_min3_f32 v7, v7, v211, v212
    v_max3_f32 v6, v6, v213, v214
    v_min3_f32 v7, v7, v213, v214
    v_max3_f32 v6, v6, v215, v216
    v_min3_f32 v7, v7, v215, v216
    v_max_f32 v6, v6, v217
    v_min_f32 v7, v7, v217
    v_pk_mul_f32 v[6:7], v[6:7], v[68:69] op_sel_hi:[1,0]
    v_pk_fma_f32 v[218:219], v[198:199], v[68:69], v[6:7] op_sel_hi:[1,0,0] neg_lo:[0,0,1] neg_hi:[0,0,1]
    v_pk_fma_f32 v[220:221], v[200:201], v[68:69], v[6:7] op_sel_hi:[1,0,0] neg_lo:[0,0,1] neg_hi:[0,0,1]
    v_pk_fma_f32 v[222:223], v[202:203], v[68:69], v[6:7] op_sel_hi:[1,0,0] neg_lo:[0,0,1] neg_hi:[0,0,1]
    v_pk_fma_f32 v[224:225], v[204:205], v[68:69], v[6:7] op_sel_hi:[1,0,0] neg_lo:[0,0,1] neg_hi:[0,0,1]
    v_pk_fma_f32 v[226:227], v[206:207], v[68:69], v[6:7] op_sel_hi:[1,0,0] neg_lo:[0,0,1] neg_hi:[0,0,1]
    v_pk_fma_f32 v[228:229], v[208:209], v[68:69], v[6:7] op_sel_hi:[1,0,0] neg_lo:[0,0,1] neg_hi:[0,0,1]
    v_pk_fma_f32 v[230:231], v[210:211], v[68:69], v[6:7] op_sel_hi:[1,0,0] neg_lo:[0,0,1] neg_hi:[0,0,1]
    v_pk_fma_f32 v[232:233], v[212:213], v[68:69], v[6:7] op_sel_hi:[1,0,0] neg_lo:[0,0,1] neg_hi:[0,0,1]
    v_pk_fma_f32 v[234:235], v[214:215], v[68:69], v[6:7] op_sel_hi:[1,0,0] neg_lo:[0,0,1] neg_hi:[0,0,1]
    v_pk_fma_f32 v[236:237], v[216:217], v[68:69], v[6:7] op_sel_hi:[1,0,0] neg_lo:[0,0,1] neg_hi:[0,0,1]
    v_exp_f32 v218, v218
    v_exp_f32 v219, v219
    v_exp_f32 v220, v220
    v_exp_f32 v221, v221
    v_exp_f32 v222, v222
    v_exp_f32 v223, v223
    v_exp_f32 v224, v224
    v_exp_f32 v225, v225
    v_exp_f32 v226, v226
    v_exp_f32 v227, v227
    s_add_u32 m0, s65, 26080
    v_exp_f32 v228, v228
    buffer_load_dwordx4 v154, s[12:15], s85 offen lds
    v_exp_f32 v229, v229
    v_exp_f32 v230, v230
    v_exp_f32 v231, v231
    v_exp_f32 v232, v232
    v_exp_f32 v233, v233
    v_exp_f32 v234, v234
    v_exp_f32 v235, v235
    v_exp_f32 v236, v236
    v_exp_f32 v237, v237
    v_pk_add_f32 v[8:9], v[218:219], v[220:221]
    v_pk_add_f32 v[8:9], v[8:9], v[222:223]
    v_pk_add_f32 v[8:9], v[8:9], v[224:225]
    v_pk_add_f32 v[8:9], v[8:9], v[226:227]
    v_pk_add_f32 v[8:9], v[8:9], v[228:229]
    v_pk_add_f32 v[8:9], v[8:9], v[230:231]
    v_pk_add_f32 v[8:9], v[8:9], v[232:233]
    v_pk_add_f32 v[8:9], v[8:9], v[234:235]
    v_pk_add_f32 v[8:9], v[8:9], v[236:237]
    v_add_f32 v8, v8, v9
    v_rcp_f32 v8, v8
    s_nop 0
    v_pk_mul_f32 v[218:219], v[218:219], v[8:9] op_sel_hi:[1,0]
    v_cvt_pk_bf16_f32 v70, v218, v219
    v_pk_mul_f32 v[220:221], v[220:221], v[8:9] op_sel_hi:[1,0]
    v_cvt_pk_bf16_f32 v71, v220, v221
    v_pk_mul_f32 v[222:223], v[222:223], v[8:9] op_sel_hi:[1,0]
    v_cvt_pk_bf16_f32 v72, v222, v223
    v_pk_mul_f32 v[224:225], v[224:225], v[8:9] op_sel_hi:[1,0]
    v_cvt_pk_bf16_f32 v73, v224, v225
    ds_write_b128 v153, v[70:73] offset:0
    v_pk_mul_f32 v[226:227], v[226:227], v[8:9] op_sel_hi:[1,0]
    v_cvt_pk_bf16_f32 v74, v226, v227
    s_add_u32 m0, s65, 31296
    v_pk_mul_f32 v[228:229], v[228:229], v[8:9] op_sel_hi:[1,0]
    buffer_load_dwordx4 v154, s[12:15], s86 offen lds
    v_cvt_pk_bf16_f32 v75, v228, v229
    v_pk_mul_f32 v[230:231], v[230:231], v[8:9] op_sel_hi:[1,0]
    v_cvt_pk_bf16_f32 v76, v230, v231
    v_pk_mul_f32 v[232:233], v[232:233], v[8:9] op_sel_hi:[1,0]
    v_cvt_pk_bf16_f32 v77, v232, v233
    ds_write_b128 v153, v[74:77] offset:16
    v_pk_mul_f32 v[234:235], v[234:235], v[8:9] op_sel_hi:[1,0]
    v_cvt_pk_bf16_f32 v78, v234, v235
    v_pk_mul_f32 v[236:237], v[236:237], v[8:9] op_sel_hi:[1,0]
    v_cvt_pk_bf16_f32 v79, v236, v237
    v_pk_fma_f32 v[218:219], v[198:199], v[68:69], v[6:7] op_sel:[0,0,1] op_sel_hi:[1,0,1] neg_lo:[1,0,0] neg_hi:[1,0,0]
    v_pk_fma_f32 v[220:221], v[200:201], v[68:69], v[6:7] op_sel:[0,0,1] op_sel_hi:[1,0,1] neg_lo:[1,0,0] neg_hi:[1,0,0]
    v_pk_fma_f32 v[222:223], v[202:203], v[68:69], v[6:7] op_sel:[0,0,1] op_sel_hi:[1,0,1] neg_lo:[1,0,0] neg_hi:[1,0,0]
    v_pk_fma_f32 v[224:225], v[204:205], v[68:69], v[6:7] op_sel:[0,0,1] op_sel_hi:[1,0,1] neg_lo:[1,0,0] neg_hi:[1,0,0]
    v_pk_fma_f32 v[226:227], v[206:207], v[68:69], v[6:7] op_sel:[0,0,1] op_sel_hi:[1,0,1] neg_lo:[1,0,0] neg_hi:[1,0,0]
    v_pk_fma_f32 v[228:229], v[208:209], v[68:69], v[6:7] op_sel:[0,0,1] op_sel_hi:[1,0,1] neg_lo:[1,0,0] neg_hi:[1,0,0]
    v_pk_fma_f32 v[230:231], v[210:211], v[68:69], v[6:7] op_sel:[0,0,1] op_sel_hi:[1,0,1] neg_lo:[1,0,0] neg_hi:[1,0,0]
    v_pk_fma_f32 v[232:233], v[212:213], v[68:69], v[6:7] op_sel:[0,0,1] op_sel_hi:[1,0,1] neg_lo:[1,0,0] neg_hi:[1,0,0]
    v_pk_fma_f32 v[234:235], v[214:215], v[68:69], v[6:7] op_sel:[0,0,1] op_sel_hi:[1,0,1] neg_lo:[1,0,0] neg_hi:[1,0,0]
    v_pk_fma_f32 v[236:237], v[216:217], v[68:69], v[6:7] op_sel:[0,0,1] op_sel_hi:[1,0,1] neg_lo:[1,0,0] neg_hi:[1,0,0]
    v_exp_f32 v218, v218
    v_exp_f32 v219, v219
    v_exp_f32 v220, v220
    v_exp_f32 v221, v221
    v_exp_f32 v222, v222
    v_exp_f32 v223, v223
    v_exp_f32 v224, v224
    v_exp_f32 v225, v225
    v_exp_f32 v226, v226
    v_exp_f32 v227, v227
    v_exp_f32 v228, v228
    s_add_u32 m0, s65, 36512
    v_exp_f32 v229, v229
    buffer_load_dwordx4 v154, s[12:15], s87 offen lds
    v_exp_f32 v230, v230
    v_exp_f32 v231, v231
    v_exp_f32 v232, v232
    v_exp_f32 v233, v233
    v_exp_f32 v234, v234
    v_exp_f32 v235, v235
    v_exp_f32 v236, v236
    v_exp_f32 v237, v237
    v_pk_add_f32 v[8:9], v[218:219], v[220:221]
    v_pk_add_f32 v[8:9], v[8:9], v[222:223]
    v_pk_add_f32 v[8:9], v[8:9], v[224:225]
    v_pk_add_f32 v[8:9], v[8:9], v[226:227]
    v_pk_add_f32 v[8:9], v[8:9], v[228:229]
    v_pk_add_f32 v[8:9], v[8:9], v[230:231]
    v_pk_add_f32 v[8:9], v[8:9], v[232:233]
    v_pk_add_f32 v[8:9], v[8:9], v[234:235]
    v_pk_add_f32 v[8:9], v[8:9], v[236:237]
    v_add_f32 v8, v8, v9
    v_rcp_f32 v8, v8
    s_nop 0
    v_pk_mul_f32 v[218:219], v[218:219], v[8:9] op_sel_hi:[1,0]
    v_cvt_pk_bf16_f32 v80, v218, v219
    v_pk_mul_f32 v[220:221], v[220:221], v[8:9] op_sel_hi:[1,0]
    v_cvt_pk_bf16_f32 v81, v220, v221
    ds_write_b128 v153, v[78:81] offset:32
    v_pk_mul_f32 v[222:223], v[222:223], v[8:9] op_sel_hi:[1,0]
    v_cvt_pk_bf16_f32 v82, v222, v223
    v_pk_mul_f32 v[224:225], v[224:225], v[8:9] op_sel_hi:[1,0]
    v_cvt_pk_bf16_f32 v83, v224, v225
    v_pk_mul_f32 v[226:227], v[226:227], v[8:9] op_sel_hi:[1,0]
    v_cvt_pk_bf16_f32 v84, v226, v227
    v_pk_mul_f32 v[228:229], v[228:229], v[8:9] op_sel_hi:[1,0]
    v_cvt_pk_bf16_f32 v85, v228, v229
    s_add_u32 m0, s68, 4096
    ds_write_b128 v153, v[82:85] offset:48
    buffer_load_dwordx4 v155, s[12:15], s69 offen lds
    v_pk_mul_f32 v[230:231], v[230:231], v[8:9] op_sel_hi:[1,0]
    v_cvt_pk_bf16_f32 v86, v230, v231
    v_pk_mul_f32 v[232:233], v[232:233], v[8:9] op_sel_hi:[1,0]
    v_cvt_pk_bf16_f32 v87, v232, v233
    v_pk_mul_f32 v[234:235], v[234:235], v[8:9] op_sel_hi:[1,0]
    v_cvt_pk_bf16_f32 v88, v234, v235
    v_pk_mul_f32 v[236:237], v[236:237], v[8:9] op_sel_hi:[1,0]
    v_cvt_pk_bf16_f32 v89, v236, v237
    ds_write_b128 v153, v[86:89] offset:64
    s_waitcnt vmcnt(7)
    s_cmp_ge_u32 s64, 480
    s_cbranch_scc1 L_nr10
    ds_read_b64_tr_b16 v[102:103], v255 offset:0
    ds_read_b64_tr_b16 v[104:105], v255 offset:512
    ds_read_b64_tr_b16 v[106:107], v255 offset:1024
    ds_read_b64_tr_b16 v[108:109], v255 offset:1536
    ds_read_b64_tr_b16 v[110:111], v255 offset:2048
    ds_read_b64_tr_b16 v[112:113], v255 offset:2560
    ds_read_b64_tr_b16 v[114:115], v255 offset:3072
    ds_read_b64_tr_b16 v[116:117], v255 offset:3584
    ds_read_b64_tr_b16 v[118:119], v255 offset:4096
    ds_read_b64_tr_b16 v[120:121], v255 offset:4608
    ds_read_b64_tr_b16 v[122:123], v255 offset:5120
    ds_read_b64_tr_b16 v[124:125], v255 offset:5632
    s_add_u32 s96, s74, 0
    s_lshr_b32 s97, s96, 2
    s_lshl4_add_u32 s96, s97, s96
    s_lshl_b32 s96, s96, 8
    s_add_u32 s96, s96, 16777216
    s_waitcnt lgkmcnt(0)
    buffer_store_dwordx4 v[102:105], v254, s[16:19], s96 offen sc1
    s_add_u32 s96, s74, 1
    s_lshr_b32 s97, s96, 2
    s_lshl4_add_u32 s96, s97, s96
    s_lshl_b32 s96, s96, 8
    s_add_u32 s96, s96, 16777216
    buffer_store_dwordx4 v[106:109], v254, s[16:19], s96 offen sc1
    s_add_u32 s96, s74, 2
    s_lshr_b32 s97, s96, 2
    s_lshl4_add_u32 s96, s97, s96
    s_lshl_b32 s96, s96, 8
    s_add_u32 s96, s96, 16777216
    buffer_store_dwordx4 v[110:113], v254, s[16:19], s96 offen sc1
    s_add_u32 s96, s74, 3
    s_lshr_b32 s97, s96, 2
    s_lshl4_add_u32 s96, s97, s96
    s_lshl_b32 s96, s96, 8
    s_add_u32 s96, s96, 16777216
    buffer_store_dwordx4 v[114:117], v254, s[16:19], s96 offen sc1
    s_add_u32 s96, s74, 4
    s_lshr_b32 s97, s96, 2
    s_lshl4_add_u32 s96, s97, s96
    s_lshl_b32 s96, s96, 8
    s_add_u32 s96, s96, 16777216
    buffer_store_dwordx4 v[118:121], v254, s[16:19], s96 offen sc1
    s_add_u32 s96, s76, 0
    s_lshr_b32 s97, s96, 2
    s_lshl4_add_u32 s96, s97, s96
    s_lshl_b32 s96, s96, 8
    s_add_u32 s96, s96, 16777216
    buffer_store_dwordx4 v[122:125], v254, s[16:19], s96 offen sc1
L_nr10:
    s_waitcnt lgkmcnt(0)
    s_barrier
    ds_read_b64_tr_b16 a[160:161], v177 offset:0
    ds_read_b64_tr_b16 a[162:163], v177 offset:80
    ds_read_b64_tr_b16 a[164:165], v178 offset:0
    ds_read_b64_tr_b16 a[166:167], v178 offset:48
    ds_read_b64_tr_b16 a[168:169], v177 offset:1280
    ds_read_b64_tr_b16 a[170:171], v177 offset:1360
    ds_read_b64_tr_b16 a[172:173], v178 offset:768
    ds_read_b64_tr_b16 a[174:175], v178 offset:816
    ds_read_b64_tr_b16 a[176:177], v177 offset:2560
    ds_read_b64_tr_b16 a[178:179], v177 offset:2640
    ds_read_b64_tr_b16 a[180:181], v178 offset:1536
    s_add_u32 m0, s65, 41728
    ds_read_b64_tr_b16 a[182:183], v178 offset:1584
    buffer_load_dwordx4 v154, s[12:15], s88 offen lds
    s_waitcnt lgkmcnt(8)
    v_mfma_f32_32x32x16_bf16 v[134:149], a[160:163], a[164:167], 0
    ds_read_b64_tr_b16 a[184:185], v177 offset:3840
    ds_read_b64_tr_b16 a[186:187], v177 offset:3920
    ds_read_b64_tr_b16 a[188:189], v178 offset:2304
    ds_read_b64_tr_b16 a[190:191], v178 offset:2352
    s_waitcnt lgkmcnt(8)
    v_mfma_f32_32x32x16_bf16 v[134:149], a[168:171], a[172:175], v[134:149]
    ds_read_b64_tr_b16 a[192:193], v177 offset:5120
    ds_read_b64_tr_b16 a[194:195], v177 offset:5200
    ds_read_b64_tr_b16 a[196:197], v178 offset:3072
    ds_read_b64_tr_b16 a[198:199], v178 offset:3120
    s_waitcnt lgkmcnt(8)
    v_mfma_f32_32x32x16_bf16 v[134:149], a[176:179], a[180:183], v[134:149]
    ds_read_b64_tr_b16 a[200:201], v177 offset:6400
    ds_read_b64_tr_b16 a[202:203], v177 offset:6480
    ds_read_b64_tr_b16 a[204:205], v178 offset:3840
    ds_read_b64_tr_b16 a[206:207], v178 offset:3888
    s_waitcnt lgkmcnt(8)
    v_mfma_f32_32x32x16_bf16 v[134:149], a[184:187], a[188:191], v[134:149]
    ds_read_b64_tr_b16 a[160:161], v177 offset:7680
    ds_read_b64_tr_b16 a[162:163], v177 offset:7760
    ds_read_b64_tr_b16 a[164:165], v178 offset:4608
    ds_read_b64_tr_b16 a[166:167], v178 offset:4656
    s_waitcnt lgkmcnt(8)
    v_mfma_f32_32x32x16_bf16 v[134:149], a[192:195], a[196:199], v[134:149]
    ds_read_b64_tr_b16 a[168:169], v177 offset:8960
    ds_read_b64_tr_b16 a[170:171], v177 offset:9040
    ds_read_b64_tr_b16 a[172:173], v178 offset:5376
    ds_read_b64_tr_b16 a[174:175], v178 offset:5424
    s_waitcnt lgkmcnt(8)
    v_mfma_f32_32x32x16_bf16 v[134:149], a[200:203], a[204:207], v[134:149]
    s_waitcnt lgkmcnt(4)
    v_mfma_f32_32x32x16_bf16 v[134:149], a[160:163], a[164:167], v[134:149]
    s_waitcnt lgkmcnt(0)
    v_mfma_f32_32x32x16_bf16 v[134:149], a[168:171], a[172:175], v[134:149]
    s_nop 11
    v_cvt_pk_bf16_f32 v134, v134, v135
    v_cvt_pk_bf16_f32 v135, v136, v137
    v_cvt_pk_bf16_f32 v136, v138, v139
    v_cvt_pk_bf16_f32 v137, v140, v141
    v_cvt_pk_bf16_f32 v138, v142, v143
    v_cvt_pk_bf16_f32 v139, v144, v145
    s_mov_b32 exec_lo, 0xffffff
    s_mov_b32 exec_hi, 0xffffff
    buffer_store_dwordx4 v[134:137], v180, s[16:19], s78 offen sc1
    s_cmp_lg_u32 s98, 0
    s_cbranch_scc1 L_t111
    buffer_store_dwordx2 v[138:139], v181, s[16:19], s77 offen offset:1536 sc1
L_t111:
    s_mov_b64 exec, -1
    s_waitcnt vmcnt(7)
    s_barrier
    s_add_u32 m0, s65, 46944
    s_nop 0
    buffer_load_dwordx4 v154, s[12:15], s89 offen lds
    ds_read_b64_tr_b16 a[160:161], v156 offset:0
    ds_read_b64_tr_b16 a[162:163], v156 offset:80
    ds_read_b64_tr_b16 a[164:165], v157 offset:0
    ds_read_b64_tr_b16 a[166:167], v157 offset:80
    ds_read_b64_tr_b16 a[168:169], v158 offset:0
    ds_read_b64_tr_b16 a[170:171], v158 offset:80
    ds_read_b64_tr_b16 a[172:173], v159 offset:0
    ds_read_b64_tr_b16 a[174:175], v159 offset:80
    ds_read_b64_tr_b16 a[176:177], v160 offset:0
    ds_read_b64_tr_b16 a[178:179], v160 offset:80
    ds_read_b64_tr_b16 a[180:181], v161 offset:0
    ds_read_b64_tr_b16 a[182:183], v161 offset:80
    ds_read_b64_tr_b16 a[184:185], v162 offset:0
    ds_read_b64_tr_b16 a[186:187], v162 offset:80
    ds_read_b64_tr_b16 a[188:189], v163 offset:0
    ds_read_b64_tr_b16 a[190:191], v163 offset:80
    s_waitcnt lgkmcnt(8)
    v_mfma_f32_32x32x16_bf16 v[102:117], a[160:163], a[0:3], 0
    ds_read_b64_tr_b16 a[192:193], v156 offset:5216
    ds_read_b64_tr_b16 a[194:195], v156 offset:5296
    ds_read_b64_tr_b16 a[196:197], v157 offset:5216
    v_mfma_f32_32x32x16_bf16 v[102:117], a[168:171], a[4:7], v[102:117]
    ds_read_b64_tr_b16 a[198:199], v157 offset:5296
    ds_read_b64_tr_b16 a[200:201], v158 offset:5216
    ds_read_b64_tr_b16 a[202:203], v158 offset:5296
    v_mfma_f32_16x16x32_bf16 v[32:35], v[28:31], a[160:163], 0
    ds_read_b64_tr_b16 a[204:205], v159 offset:5216
    v_mfma_f32_16x16x32_bf16 v[36:39], v[28:31], a[164:167], 0
    ds_read_b64_tr_b16 a[206:207], v159 offset:5296
    v_mfma_f32_16x16x32_bf16 v[118:121], a[164:167], a[0:3], 0
    v_mfma_f32_16x16x32_bf16 v[118:121], a[172:175], a[4:7], v[118:121]
    s_waitcnt lgkmcnt(8)
    v_mfma_f32_32x32x16_bf16 v[102:117], a[176:179], a[8:11], v[102:117]
    s_add_u32 m0, s70, 4096
    s_nop 0
    buffer_load_dwordx4 v155, s[12:15], s71 offen lds
    ds_read_b64_tr_b16 a[160:161], v160 offset:5216
    ds_read_b64_tr_b16 a[162:163], v160 offset:5296
    ds_read_b64_tr_b16 a[164:165], v161 offset:5216
    v_mfma_f32_32x32x16_bf16 v[102:117], a[184:187], a[12:15], v[102:117]
    ds_read_b64_tr_b16 a[166:167], v161 offset:5296
    ds_read_b64_tr_b16 a[168:169], v162 offset:5216
    ds_read_b64_tr_b16 a[170:171], v162 offset:5296
    v_mfma_f32_16x16x32_bf16 v[118:121], a[180:183], a[8:11], v[118:121]
    ds_read_b64_tr_b16 a[172:173], v163 offset:5216
    v_mfma_f32_16x16x32_bf16 v[118:121], a[188:191], a[12:15], v[118:121]
    ds_read_b64_tr_b16 a[174:175], v163 offset:5296
    s_waitcnt lgkmcnt(8)
    v_mfma_f32_32x32x16_bf16 v[102:117], a[192:195], a[16:19], v[102:117]
    ds_read_b64_tr_b16 a[176:177], v156 offset:10432
    ds_read_b64_tr_b16 a[178:179], v156 offset:10512
    ds_read_b64_tr_b16 a[180:181], v157 offset:10432
    v_mfma_f32_32x32x16_bf16 v[102:117], a[200:203], a[20:23], v[102:117]
    ds_read_b64_tr_b16 a[182:183], v157 offset:10512
    ds_read_b64_tr_b16 a[184:185], v158 offset:10432
    ds_read_b64_tr_b16 a[186:187], v158 offset:10512
    v_mfma_f32_16x16x32_bf16 v[32:35], v[28:31], a[192:195], v[32:35]
    ds_read_b64_tr_b16 a[188:189], v159 offset:10432
    v_mfma_f32_16x16x32_bf16 v[36:39], v[28:31], a[196:199], v[36:39]
    ds_read_b64_tr_b16 a[190:191], v159 offset:10512
    v_mfma_f32_16x16x32_bf16 v[118:121], a[196:199], a[16:19], v[118:121]
    s_lshr_b32 s36, s72, 4
    s_add_u32 m0, s36, 67584
    s_nop 0
    buffer_load_dwordx4 v46, s[24:27], s72 offen offset:0 lds
    v_mfma_f32_16x16x32_bf16 v[118:121], a[204:207], a[20:23], v[118:121]
    s_waitcnt vmcnt(3)
    s_barrier
    s_mov_b64 exec, 0x1ff
    buffer_atomic_add v15, v152, s[16:19], 0 offen sc1
    s_mov_b64 exec, -1
    buffer_load_dwordx4 v47, s[24:27], s72 offen offset:1024 lds
    s_waitcnt lgkmcnt(8)
    v_mfma_f32_32x32x16_bf16 v[102:117], a[160:163], a[24:27], v[102:117]
    ds_read_b64_tr_b16 a[192:193], v160 offset:10432
    ds_read_b64_tr_b16 a[194:195], v160 offset:10512
    ds_read_b64_tr_b16 a[196:197], v161 offset:10432
    v_mfma_f32_32x32x16_bf16 v[102:117], a[168:171], a[28:31], v[102:117]
    ds_read_b64_tr_b16 a[198:199], v161 offset:10512
    ds_read_b64_tr_b16 a[200:201], v162 offset:10432
    ds_read_b64_tr_b16 a[202:203], v162 offset:10512
    v_mfma_f32_16x16x32_bf16 v[118:121], a[164:167], a[24:27], v[118:121]
    ds_read_b64_tr_b16 a[204:205], v163 offset:10432
    v_mfma_f32_16x16x32_bf16 v[118:121], a[172:175], a[28:31], v[118:121]
    buffer_load_dwordx4 v48, s[24:27], s72 offen offset:2048 lds
    s_add_u32 s72, s72, 196608
    s_sub_u32 s96, s72, 1376256
    s_min_u32 s72, s72, s96
    ds_read_b64_tr_b16 a[206:207], v163 offset:10512
    s_waitcnt lgkmcnt(8)
    v_mfma_f32_32x32x16_bf16 v[102:117], a[176:179], a[32:35], v[102:117]
    ds_read_b64_tr_b16 a[160:161], v156 offset:15648
    ds_read_b64_tr_b16 a[162:163], v156 offset:15728
    ds_read_b64_tr_b16 a[164:165], v157 offset:15648
    v_mfma_f32_32x32x16_bf16 v[102:117], a[184:187], a[36:39], v[102:117]
    ds_read_b64_tr_b16 a[166:167], v157 offset:15728
    ds_read_b64_tr_b16 a[168:169], v158 offset:15648
    ds_read_b64_tr_b16 a[170:171], v158 offset:15728
    v_mfma_f32_16x16x32_bf16 v[32:35], v[28:31], a[176:179], v[32:35]
    ds_read_b64_tr_b16 a[172:173], v159 offset:15648
    v_mfma_f32_16x16x32_bf16 v[36:39], v[28:31], a[180:183], v[36:39]
    ds_read_b64_tr_b16 a[174:175], v159 offset:15728
    v_mfma_f32_16x16x32_bf16 v[118:121], a[180:183], a[32:35], v[118:121]
    s_lshr_b32 s36, s72, 4
    s_add_u32 m0, s36, 67584
    s_nop 0
    buffer_load_dwordx4 v46, s[24:27], s72 offen offset:0 lds
    v_mfma_f32_16x16x32_bf16 v[118:121], a[188:191], a[36:39], v[118:121]
    s_waitcnt lgkmcnt(8)
    v_mfma_f32_32x32x16_bf16 v[102:117], a[192:195], a[40:43], v[102:117]
    ds_read_b64_tr_b16 a[176:177], v160 offset:15648
    ds_read_b64_tr_b16 a[178:179], v160 offset:15728
    ds_read_b64_tr_b16 a[180:181], v161 offset:15648
    v_mfma_f32_32x32x16_bf16 v[102:117], a[200:203], a[44:47], v[102:117]
    ds_read_b64_tr_b16 a[182:183], v161 offset:15728
    ds_read_b64_tr_b16 a[184:185], v162 offset:15648
    ds_read_b64_tr_b16 a[186:187], v162 offset:15728
    v_mfma_f32_16x16x32_bf16 v[118:121], a[196:199], a[40:43], v[118:121]
    buffer_load_dwordx4 v47, s[24:27], s72 offen offset:1024 lds
    ds_read_b64_tr_b16 a[188:189], v163 offset:15648
    v_mfma_f32_16x16x32_bf16 v[118:121], a[204:207], a[44:47], v[118:121]
    ds_read_b64_tr_b16 a[190:191], v163 offset:15728
    s_waitcnt lgkmcnt(8)
    v_mfma_f32_32x32x16_bf16 v[102:117], a[160:163], a[48:51], v[102:117]
    ds_read_b64_tr_b16 a[192:193], v156 offset:20864
    ds_read_b64_tr_b16 a[194:195], v156 offset:20944
    ds_read_b64_tr_b16 a[196:197], v157 offset:20864
    v_mfma_f32_32x32x16_bf16 v[102:117], a[168:171], a[52:55], v[102:117]
    ds_read_b64_tr_b16 a[198:199], v157 offset:20944
    ds_read_b64_tr_b16 a[200:201], v158 offset:20864
    ds_read_b64_tr_b16 a[202:203], v158 offset:20944
    v_mfma_f32_16x16x32_bf16 v[32:35], v[28:31], a[160:163], v[32:35]
    buffer_load_dwordx4 v48, s[24:27], s72 offen offset:2048 lds
    s_add_u32 s72, s72, 196608
    s_sub_u32 s96, s72, 1376256
    s_min_u32 s72, s72, s96
    ds_read_b64_tr_b16 a[204:205], v159 offset:20864
    v_mfma_f32_16x16x32_bf16 v[36:39], v[28:31], a[164:167], v[36:39]
    ds_read_b64_tr_b16 a[206:207], v159 offset:20944
    v_mfma_f32_16x16x32_bf16 v[118:121], a[164:167], a[48:51], v[118:121]
    v_mfma_f32_16x16x32_bf16 v[118:121], a[172:175], a[52:55], v[118:121]
    s_waitcnt lgkmcnt(8)
    v_mfma_f32_32x32x16_bf16 v[102:117], a[176:179], a[56:59], v[102:117]
    ds_read_b64_tr_b16 a[160:161], v160 offset:20864
    ds_read_b64_tr_b16 a[162:163], v160 offset:20944
    ds_read_b64_tr_b16 a[164:165], v161 offset:20864
    v_mfma_f32_32x32x16_bf16 v[102:117], a[184:187], a[60:63], v[102:117]
    s_lshr_b32 s36, s72, 4
    s_add_u32 m0, s36, 67584
    s_nop 0
    buffer_load_dwordx4 v46, s[24:27], s72 offen offset:0 lds
    ds_read_b64_tr_b16 a[166:167], v161 offset:20944
    ds_read_b64_tr_b16 a[168:169], v162 offset:20864
    ds_read_b64_tr_b16 a[170:171], v162 offset:20944
    v_mfma_f32_16x16x32_bf16 v[118:121], a[180:183], a[56:59], v[118:121]
    ds_read_b64_tr_b16 a[172:173], v163 offset:20864
    v_mfma_f32_16x16x32_bf16 v[118:121], a[188:191], a[60:63], v[118:121]
    ds_read_b64_tr_b16 a[174:175], v163 offset:20944
    s_waitcnt lgkmcnt(8)
    v_mfma_f32_32x32x16_bf16 v[102:117], a[192:195], a[64:67], v[102:117]
    ds_read_b64_tr_b16 a[176:177], v156 offset:26080
    ds_read_b64_tr_b16 a[178:179], v156 offset:26160
    ds_read_b64_tr_b16 a[180:181], v157 offset:26080
    v_mfma_f32_32x32x16_bf16 v[102:117], a[200:203], a[68:71], v[102:117]
    buffer_load_dwordx4 v47, s[24:27], s72 offen offset:1024 lds
    ds_read_b64_tr_b16 a[182:183], v157 offset:26160
    ds_read_b64_tr_b16 a[184:185], v158 offset:26080
    ds_read_b64_tr_b16 a[186:187], v158 offset:26160
    v_mfma_f32_16x16x32_bf16 v[32:35], v[28:31], a[192:195], v[32:35]
    ds_read_b64_tr_b16 a[188:189], v159 offset:26080
    v_mfma_f32_16x16x32_bf16 v[36:39], v[28:31], a[196:199], v[36:39]
    ds_read_b64_tr_b16 a[190:191], v159 offset:26160
    v_mfma_f32_16x16x32_bf16 v[118:121], a[196:199], a[64:67], v[118:121]
    v_mfma_f32_16x16x32_bf16 v[118:121], a[204:207], a[68:71], v[118:121]
    s_waitcnt lgkmcnt(8)
    v_mfma_f32_32x32x16_bf16 v[102:117], a[160:163], a[72:75], v[102:117]
    buffer_load_dwordx4 v48, s[24:27], s72 offen offset:2048 lds
    s_add_u32 s72, s72, 196608
    s_sub_u32 s96, s72, 1376256
    s_min_u32 s72, s72, s96
    ds_read_b64_tr_b16 a[192:193], v160 offset:26080
    ds_read_b64_tr_b16 a[194:195], v160 offset:26160
    ds_read_b64_tr_b16 a[196:197], v161 offset:26080
    v_mfma_f32_32x32x16_bf16 v[102:117], a[168:171], a[76:79], v[102:117]
    ds_read_b64_tr_b16 a[198:199], v161 offset:26160
    ds_read_b64_tr_b16 a[200:201], v162 offset:26080
    ds_read_b64_tr_b16 a[202:203], v162 offset:26160
    v_mfma_f32_16x16x32_bf16 v[118:121], a[164:167], a[72:75], v[118:121]
    ds_read_b64_tr_b16 a[204:205], v163 offset:26080
    v_mfma_f32_16x16x32_bf16 v[118:121], a[172:175], a[76:79], v[118:121]
    ds_read_b64_tr_b16 a[206:207], v163 offset:26160
    s_waitcnt lgkmcnt(8)
    v_mfma_f32_32x32x16_bf16 v[102:117], a[176:179], a[80:83], v[102:117]
    s_lshr_b32 s36, s72, 4
    s_add_u32 m0, s36, 67584
    s_nop 0
    buffer_load_dwordx4 v46, s[24:27], s72 offen offset:0 lds
    ds_read_b64_tr_b16 a[160:161], v156 offset:31296
    ds_read_b64_tr_b16 a[162:163], v156 offset:31376
    ds_read_b64_tr_b16 a[164:165], v157 offset:31296
    v_mfma_f32_32x32x16_bf16 v[102:117], a[184:187], a[84:87], v[102:117]
    ds_read_b64_tr_b16 a[166:167], v157 offset:31376
    ds_read_b64_tr_b16 a[168:169], v158 offset:31296
    ds_read_b64_tr_b16 a[170:171], v158 offset:31376
    v_mfma_f32_16x16x32_bf16 v[32:35], v[28:31], a[176:179], v[32:35]
    ds_read_b64_tr_b16 a[172:173], v159 offset:31296
    v_mfma_f32_16x16x32_bf16 v[36:39], v[28:31], a[180:183], v[36:39]
    ds_read_b64_tr_b16 a[174:175], v159 offset:31376
    v_mfma_f32_16x16x32_bf16 v[118:121], a[180:183], a[80:83], v[118:121]
    v_mfma_f32_16x16x32_bf16 v[118:121], a[188:191], a[84:87], v[118:121]
    buffer_load_dwordx4 v47, s[24:27], s72 offen offset:1024 lds
    v_mov_b32 v17, 0
    s_mov_b64 exec, 1
    buffer_atomic_add v17, v152, s[16:19], 0 offen sc0 sc1
    s_mov_b64 exec, -1
    s_waitcnt lgkmcnt(8)
    v_mfma_f32_32x32x16_bf16 v[102:117], a[192:195], a[88:91], v[102:117]
    ds_read_b64_tr_b16 a[176:177], v160 offset:31296
    ds_read_b64_tr_b16 a[178:179], v160 offset:31376
    ds_read_b64_tr_b16 a[180:181], v161 offset:31296
    v_mfma_f32_32x32x16_bf16 v[102:117], a[200:203], a[92:95], v[102:117]
    ds_read_b64_tr_b16 a[182:183], v161 offset:31376
    ds_read_b64_tr_b16 a[184:185], v162 offset:31296
    ds_read_b64_tr_b16 a[186:187], v162 offset:31376
    v_mfma_f32_16x16x32_bf16 v[118:121], a[196:199], a[88:91], v[118:121]
    ds_read_b64_tr_b16 a[188:189], v163 offset:31296
    v_mfma_f32_16x16x32_bf16 v[118:121], a[204:207], a[92:95], v[118:121]
    buffer_load_dwordx4 v48, s[24:27], s72 offen offset:2048 lds
    s_add_u32 s72, s72, 196608
    s_sub_u32 s96, s72, 1376256
    s_min_u32 s72, s72, s96
    ds_read_b64_tr_b16 a[190:191], v163 offset:31376
    s_waitcnt lgkmcnt(8)
    v_mfma_f32_32x32x16_bf16 v[102:117], a[160:163], a[96:99], v[102:117]
    ds_read_b64_tr_b16 a[192:193], v156 offset:36512
    ds_read_b64_tr_b16 a[194:195], v156 offset:36592
    ds_read_b64_tr_b16 a[196:197], v157 offset:36512
    v_mfma_f32_32x32x16_bf16 v[102:117], a[168:171], a[100:103], v[102:117]
    ds_read_b64_tr_b16 a[198:199], v157 offset:36592
    ds_read_b64_tr_b16 a[200:201], v158 offset:36512
    ds_read_b64_tr_b16 a[202:203], v158 offset:36592
    v_mfma_f32_16x16x32_bf16 v[32:35], v[28:31], a[160:163], v[32:35]
    ds_read_b64_tr_b16 a[204:205], v159 offset:36512
    v_mfma_f32_16x16x32_bf16 v[36:39], v[28:31], a[164:167], v[36:39]
    s_lshr_b32 s36, s72, 4
    s_add_u32 m0, s36, 67584
    s_nop 0
    buffer_load_dwordx4 v46, s[24:27], s72 offen offset:0 lds
    ds_read_b64_tr_b16 a[206:207], v159 offset:36592
    v_mfma_f32_16x16x32_bf16 v[118:121], a[164:167], a[96:99], v[118:121]
    v_mfma_f32_16x16x32_bf16 v[118:121], a[172:175], a[100:103], v[118:121]
    s_waitcnt lgkmcnt(8)
    v_mfma_f32_32x32x16_bf16 v[102:117], a[176:179], a[104:107], v[102:117]
    ds_read_b64_tr_b16 a[160:161], v160 offset:36512
    ds_read_b64_tr_b16 a[162:163], v160 offset:36592
    ds_read_b64_tr_b16 a[164:165], v161 offset:36512
    v_mfma_f32_32x32x16_bf16 v[102:117], a[184:187], a[108:111], v[102:117]
    buffer_load_dwordx4 v47, s[24:27], s72 offen offset:1024 lds
    ds_read_b64_tr_b16 a[166:167], v161 offset:36592
    ds_read_b64_tr_b16 a[168:169], v162 offset:36512
    ds_read_b64_tr_b16 a[170:171], v162 offset:36592
    v_mfma_f32_16x16x32_bf16 v[118:121], a[180:183], a[104:107], v[118:121]
    ds_read_b64_tr_b16 a[172:173], v163 offset:36512
    v_mfma_f32_16x16x32_bf16 v[118:121], a[188:191], a[108:111], v[118:121]
    ds_read_b64_tr_b16 a[174:175], v163 offset:36592
    s_waitcnt vmcnt(16)
    s_waitcnt vmcnt(3)
    v_readfirstlane_b32 s97, v17
    s_nop 1
    s_cmp_ge_u32 s97, s21
    s_cbranch_scc1 L_pout13
    s_mov_b32 s3, 0
L_poll12:
    v_mov_b32 v17, 0
    s_mov_b64 exec, 1
    buffer_atomic_add v17, v152, s[16:19], 0 offen sc0 sc1
    s_mov_b64 exec, -1
    s_add_u32 s3, s3, 1
    s_waitcnt vmcnt(0)
    s_cmp_gt_u32 s3, 0x40000
    s_cbranch_scc1 L_pout13
    v_readfirstlane_b32 s97, v17
    s_nop 1
    s_cmp_lt_u32 s97, s21
    s_cbranch_scc1 L_poll12
L_pout13:
    s_barrier
    s_add_u32 s96, s28, 0
    buffer_load_dwordx4 a[0:3], v151, s[16:19], s96 offen sc1
    s_waitcnt lgkmcnt(8)
    v_mfma_f32_32x32x16_bf16 v[102:117], a[192:195], a[112:115], v[102:117]
    ds_read_b64_tr_b16 a[176:177], v156 offset:41728
    ds_read_b64_tr_b16 a[178:179], v156 offset:41808
    ds_read_b64_tr_b16 a[180:181], v157 offset:41728
    v_mfma_f32_32x32x16_bf16 v[102:117], a[200:203], a[116:119], v[102:117]
    s_add_u32 s96, s28, 3840
    buffer_load_dwordx4 a[4:7], v151, s[16:19], s96 offen sc1
    ds_read_b64_tr_b16 a[182:183], v157 offset:41808
    ds_read_b64_tr_b16 a[184:185], v156 offset:46944
    ds_read_b64_tr_b16 a[186:187], v156 offset:47024
    v_mfma_f32_16x16x32_bf16 v[32:35], v[28:31], a[192:195], v[32:35]
    ds_read_b64_tr_b16 a[188:189], v157 offset:46944
    v_mfma_f32_16x16x32_bf16 v[36:39], v[28:31], a[196:199], v[36:39]
    s_add_u32 s96, s28, 7680
    buffer_load_dwordx4 a[8:11], v151, s[16:19], s96 offen sc1
    ds_read_b64_tr_b16 a[190:191], v157 offset:47024
L_pad2:
    s_cbranch_execz L_pad6
    v_mfma_f32_16x16x32_bf16 v[118:121], a[196:199], a[112:115], v[118:121]
    v_mfma_f32_16x16x32_bf16 v[118:121], a[204:207], a[116:119], v[118:121]
    s_waitcnt lgkmcnt(8)
    v_mfma_f32_32x32x16_bf16 v[102:117], a[160:163], a[120:123], v[102:117]
    s_add_u32 s96, s28, 11520
    buffer_load_dwordx4 a[12:15], v151, s[16:19], s96 offen sc1
    ds_read_b64_tr_b16 a[192:193], v158 offset:41728
    ds_read_b64_tr_b16 a[194:195], v158 offset:41808
    ds_read_b64_tr_b16 a[196:197], v159 offset:41728
    v_mfma_f32_32x32x16_bf16 v[102:117], a[168:171], a[124:127], v[102:117]
    s_add_u32 s96, s28, 15360
    buffer_load_dwordx4 a[16:19], v151, s[16:19], s96 offen sc1
    ds_read_b64_tr_b16 a[198:199], v159 offset:41808
    ds_read_b64_tr_b16 a[200:201], v160 offset:41728
    ds_read_b64_tr_b16 a[202:203], v160 offset:41808
    v_mfma_f32_16x16x32_bf16 v[118:121], a[164:167], a[120:123], v[118:121]
    ds_read_b64_tr_b16 a[204:205], v161 offset:41728
    v_mfma_f32_16x16x32_bf16 v[118:121], a[172:175], a[124:127], v[118:121]
    s_add_u32 s96, s28, 19200
    buffer_load_dwordx4 a[20:23], v151, s[16:19], s96 offen sc1
    ds_read_b64_tr_b16 a[206:207], v161 offset:41808
    s_waitcnt lgkmcnt(8)
    v_mfma_f32_32x32x16_bf16 v[102:117], a[176:179], a[128:131], v[102:117]
    ds_read_b64_tr_b16 a[160:161], v162 offset:41728
    ds_read_b64_tr_b16 a[162:163], v162 offset:41808
    ds_read_b64_tr_b16 a[164:165], v163 offset:41728
    v_mfma_f32_32x32x16_bf16 v[102:117], a[184:187], a[144:147], v[102:117]
    s_add_u32 s96, s28, 23040
    buffer_load_dwordx4 a[24:27], v151, s[16:19], s96 offen sc1
    ds_read_b64_tr_b16 a[166:167], v163 offset:41808
    ds_read_b64_tr_b16 a[168:169], v158 offset:46944
    ds_read_b64_tr_b16 a[170:171], v158 offset:47024
    v_mfma_f32_16x16x32_bf16 v[32:35], v[28:31], a[176:179], v[32:35]
    ds_read_b64_tr_b16 a[172:173], v159 offset:46944
    v_mfma_f32_16x16x32_bf16 v[36:39], v[28:31], a[180:183], v[36:39]
    s_add_u32 s96, s28, 26880
    buffer_load_dwordx4 a[28:31], v151, s[16:19], s96 offen sc1
    ds_read_b64_tr_b16 a[174:175], v159 offset:47024
    v_mfma_f32_16x16x32_bf16 v[32:35], v[28:31], a[184:187], v[32:35]
    v_mfma_f32_16x16x32_bf16 v[36:39], v[28:31], a[188:191], v[36:39]
    v_mfma_f32_16x16x32_bf16 v[118:121], a[180:183], a[128:131], v[118:121]
    s_add_u32 s96, s28, 30720
    buffer_load_dwordx4 a[32:35], v151, s[16:19], s96 offen sc1
    v_mfma_f32_16x16x32_bf16 v[118:121], a[188:191], a[144:147], v[118:121]
    s_waitcnt lgkmcnt(8)
    v_mfma_f32_32x32x16_bf16 v[102:117], a[192:195], a[132:135], v[102:117]
    s_add_u32 s96, s28, 34560
    buffer_load_dwordx4 a[36:39], v151, s[16:19], s96 offen sc1
    ds_read_b64_tr_b16 a[176:177], v160 offset:46944
    ds_read_b64_tr_b16 a[178:179], v160 offset:47024
    ds_read_b64_tr_b16 a[180:181], v161 offset:46944
    v_mov_b32 v33, v36
    ds_write_b128 v44, v[32:35]
    s_add_u32 s96, s28, 38400
    buffer_load_dwordx4 a[40:43], v151, s[16:19], s96 offen sc1
    v_mfma_f32_32x32x16_bf16 v[102:117], a[200:203], a[136:139], v[102:117]
    ds_read_b64_tr_b16 a[182:183], v161 offset:47024
    ds_read_b64_tr_b16 a[184:185], v162 offset:46944
    ds_read_b64_tr_b16 a[186:187], v162 offset:47024
    v_mfma_f32_16x16x32_bf16 v[118:121], a[196:199], a[132:135], v[118:121]
    s_add_u32 s96, s28, 42240
    buffer_load_dwordx4 a[44:47], v151, s[16:19], s96 offen sc1
    ds_read_b64_tr_b16 a[188:189], v163 offset:46944
    v_mfma_f32_16x16x32_bf16 v[118:121], a[204:207], a[136:139], v[118:121]
    ds_read_b64_tr_b16 a[190:191], v163 offset:47024
    s_waitcnt lgkmcnt(9)
    v_mfma_f32_32x32x16_bf16 v[102:117], a[160:163], a[140:143], v[102:117]
    s_add_u32 s96, s28, 46080
    buffer_load_dwordx4 a[48:51], v151, s[16:19], s96 offen sc1
    s_waitcnt lgkmcnt(0)
    s_barrier
    ds_read_b128 v[182:185], v45 offset:0
    ds_read_b128 v[186:189], v45 offset:1024
    ds_read_b128 v[190:193], v45 offset:2048
    ds_read_b128 v[194:197], v45 offset:3072
    v_mfma_f32_32x32x16_bf16 v[102:117], a[168:171], a[148:151], v[102:117]
    v_mfma_f32_16x16x32_bf16 v[118:121], a[164:167], a[140:143], v[118:121]
    s_add_u32 s96, s28, 49920
    buffer_load_dwordx4 a[52:55], v151, s[16:19], s96 offen sc1
    s_waitcnt lgkmcnt(2)
    v_add_f32 v182, v182, v186
    v_add_f32 v183, v183, v187
    v_mfma_f32_16x16x32_bf16 v[118:121], a[172:175], a[148:151], v[118:121]
    s_waitcnt lgkmcnt(0)
    v_add_f32 v190, v190, v194
    v_add_f32 v191, v191, v195
    v_mfma_f32_32x32x16_bf16 v[102:117], a[176:179], a[152:155], v[102:117]
    s_add_u32 s96, s28, 53760
    buffer_load_dwordx4 a[56:59], v151, s[16:19], s96 offen sc1
    v_add_f32 v182, v182, v190
    v_add_f32 v183, v183, v191
    v_cvt_pk_bf16_f32 v61, v182, 0
    v_lshlrev_b32 v187, 16, v61
    v_sub_f32 v188, v182, v187
    v_mfma_f32_32x32x16_bf16 v[102:117], a[184:187], a[156:159], v[102:117]
    s_add_u32 s96, s28, 57600
    buffer_load_dwordx4 a[60:63], v151, s[16:19], s96 offen sc1
    v_cvt_pk_bf16_f32 v60, v187, v188
    v_cvt_pk_bf16_f32 v63, v183, 0
    v_lshlrev_b32 v187, 16, v63
    v_sub_f32 v188, v183, v187
    v_cvt_pk_bf16_f32 v62, v187, v188
    v_mfma_f32_16x16x32_bf16 v[118:121], a[180:183], a[152:155], v[118:121]
    v_mfma_f32_16x16x32_bf16 v[118:121], a[188:191], a[156:159], v[118:121]
    v_mfma_f32_16x16x32_bf16 v[118:121], v[62:65], v[24:27], v[118:121]
    v_mfma_f32_32x32x16_bf16 v[102:117], v[60:63], v[24:27], v[102:117]
    v_mov_b32 v17, 0
    s_mov_b64 exec, 1
    buffer_atomic_add v17, off, s[16:19], s1 sc0 sc1
    s_mov_b64 exec, -1
    s_nop 7
    v_cvt_pk_bf16_f32 v90, v102, v103
    v_cvt_pk_bf16_f32 v91, v104, v105
    v_cvt_pk_bf16_f32 v92, v106, v107
    v_cvt_pk_bf16_f32 v93, v108, v109
    v_cvt_pk_bf16_f32 v94, v110, v111
    s_waitcnt vmcnt(16)
    v_mfma_f32_32x32x16_bf16 v[182:197], v[56:59], a[0:3], 0
    v_cvt_pk_bf16_f32 v95, v112, v113
    v_cvt_pk_bf16_f32 v96, v114, v115
    v_cvt_pk_bf16_f32 v97, v116, v117
    v_cvt_pk_bf16_f32 v98, v118, v119
    v_cvt_pk_bf16_f32 v99, v120, v121
    v_mfma_f32_32x32x16_bf16 v[198:213], a[208:211], v[90:93], 0
    v_mov_b32 v162, 0
    v_mov_b32 v163, 0
    v_mov_b32 v174, 0
    v_mov_b32 v175, 0
    v_mfma_f32_32x32x16_bf16 v[198:213], a[212:215], v[94:97], v[198:213]
    v_mfma_f32_32x32x16_bf16 v[198:213], a[216:219], v[98:101], v[198:213]
    v_mfma_f32_16x16x32_bf16 v[214:217], a[220:223], v[90:93], 0
    v_mfma_f32_16x16x32_bf16 v[214:217], a[224:227], v[94:97], v[214:217]
    v_mfma_f32_16x16x32_bf16 v[214:217], a[228:231], v[98:101], v[214:217]
    s_waitcnt vmcnt(15)
    v_mfma_f32_32x32x16_bf16 v[182:197], v[56:59], a[4:7], v[182:197]
    buffer_load_dwordx4 v48, s[24:27], s72 offen offset:2048 lds
    s_add_u32 s72, s72, 196608
    s_sub_u32 s96, s72, 1376256
    s_min_u32 s72, s72, s96
    s_nop 2
    v_max3_f32 v6, v198, v199, v200
    v_min3_f32 v7, v198, v199, v200
    s_waitcnt vmcnt(15)
    v_mfma_f32_32x32x16_bf16 v[182:197], v[56:59], a[8:11], v[182:197]
    v_max3_f32 v6, v6, v201, v202
    v_min3_f32 v7, v7, v201, v202
    v_max3_f32 v6, v6, v203, v204
    v_min3_f32 v7, v7, v203, v204
    v_max3_f32 v6, v6, v205, v206
    v_min3_f32 v7, v7, v205, v206
    s_waitcnt vmcnt(14)
    v_mfma_f32_32x32x16_bf16 v[182:197], v[56:59], a[12:15], v[182:197]
    s_lshr_b32 s36, s72, 4
    s_add_u32 m0, s36, 67584
    s_nop 0
    buffer_load_dwordx4 v46, s[24:27], s72 offen offset:0 lds
    v_max3_f32 v6, v6, v207, v208
    v_min3_f32 v7, v7, v207, v208
    v_max3_f32 v6, v6, v209, v210
    v_min3_f32 v7, v7, v209, v210
    v_max3_f32 v6, v6, v211, v212
    v_min3_f32 v7, v7, v211, v212
    v_max3_f32 v6, v6, v213, v214
    v_min3_f32 v7, v7, v213, v214
    v_max3_f32 v6, v6, v215, v216
    v_min3_f32 v7, v7, v215, v216
    v_max_f32 v6, v6, v217
    v_min_f32 v7, v7, v217
    v_pk_mul_f32 v[6:7], v[6:7], v[68:69] op_sel_hi:[1,0]
    v_pk_fma_f32 v[218:219], v[198:199], v[68:69], v[6:7] op_sel_hi:[1,0,0] neg_lo:[0,0,1] neg_hi:[0,0,1]
    v_pk_fma_f32 v[220:221], v[200:201], v[68:69], v[6:7] op_sel_hi:[1,0,0] neg_lo:[0,0,1] neg_hi:[0,0,1]
    v_pk_fma_f32 v[222:223], v[202:203], v[68:69], v[6:7] op_sel_hi:[1,0,0] neg_lo:[0,0,1] neg_hi:[0,0,1]
    v_pk_fma_f32 v[224:225], v[204:205], v[68:69], v[6:7] op_sel_hi:[1,0,0] neg_lo:[0,0,1] neg_hi:[0,0,1]
    v_pk_fma_f32 v[226:227], v[206:207], v[68:69], v[6:7] op_sel_hi:[1,0,0] neg_lo:[0,0,1] neg_hi:[0,0,1]
    v_pk_fma_f32 v[228:229], v[208:209], v[68:69], v[6:7] op_sel_hi:[1,0,0] neg_lo:[0,0,1] neg_hi:[0,0,1]
    v_pk_fma_f32 v[230:231], v[210:211], v[68:69], v[6:7] op_sel_hi:[1,0,0] neg_lo:[0,0,1] neg_hi:[0,0,1]
    v_pk_fma_f32 v[232:233], v[212:213], v[68:69], v[6:7] op_sel_hi:[1,0,0] neg_lo:[0,0,1] neg_hi:[0,0,1]
    v_pk_fma_f32 v[234:235], v[214:215], v[68:69], v[6:7] op_sel_hi:[1,0,0] neg_lo:[0,0,1] neg_hi:[0,0,1]
    v_pk_fma_f32 v[236:237], v[216:217], v[68:69], v[6:7] op_sel_hi:[1,0,0] neg_lo:[0,0,1] neg_hi:[0,0,1]
    v_pk_fma_f32 v[198:199], v[198:199], v[68:69], v[6:7] op_sel:[0,0,1] op_sel_hi:[1,0,1] neg_lo:[1,0,0] neg_hi:[1,0,0]
    v_pk_fma_f32 v[200:201], v[200:201], v[68:69], v[6:7] op_sel:[0,0,1] op_sel_hi:[1,0,1] neg_lo:[1,0,0] neg_hi:[1,0,0]
    v_pk_fma_f32 v[202:203], v[202:203], v[68:69], v[6:7] op_sel:[0,0,1] op_sel_hi:[1,0,1] neg_lo:[1,0,0] neg_hi:[1,0,0]
    v_pk_fma_f32 v[204:205], v[204:205], v[68:69], v[6:7] op_sel:[0,0,1] op_sel_hi:[1,0,1] neg_lo:[1,0,0] neg_hi:[1,0,0]
    v_pk_fma_f32 v[206:207], v[206:207], v[68:69], v[6:7] op_sel:[0,0,1] op_sel_hi:[1,0,1] neg_lo:[1,0,0] neg_hi:[1,0,0]
    buffer_load_dwordx4 v47, s[24:27], s72 offen offset:1024 lds
    v_pk_fma_f32 v[208:209], v[208:209], v[68:69], v[6:7] op_sel:[0,0,1] op_sel_hi:[1,0,1] neg_lo:[1,0,0] neg_hi:[1,0,0]
    v_pk_fma_f32 v[210:211], v[210:211], v[68:69], v[6:7] op_sel:[0,0,1] op_sel_hi:[1,0,1] neg_lo:[1,0,0] neg_hi:[1,0,0]
    v_pk_fma_f32 v[212:213], v[212:213], v[68:69], v[6:7] op_sel:[0,0,1] op_sel_hi:[1,0,1] neg_lo:[1,0,0] neg_hi:[1,0,0]
    v_pk_fma_f32 v[214:215], v[214:215], v[68:69], v[6:7] op_sel:[0,0,1] op_sel_hi:[1,0,1] neg_lo:[1,0,0] neg_hi:[1,0,0]
    v_pk_fma_f32 v[216:217], v[216:217], v[68:69], v[6:7] op_sel:[0,0,1] op_sel_hi:[1,0,1] neg_lo:[1,0,0] neg_hi:[1,0,0]
    s_waitcnt vmcnt(15)
    v_mfma_f32_32x32x16_bf16 v[182:197], v[56:59], a[16:19], v[182:197]
    v_exp_f32 v218, v218
    v_exp_f32 v219, v219
    v_exp_f32 v220, v220
    s_waitcnt vmcnt(14)
    v_mfma_f32_32x32x16_bf16 v[182:197], v[56:59], a[20:23], v[182:197]
    v_exp_f32 v221, v221
    v_exp_f32 v222, v222
    v_exp_f32 v223, v223
    s_waitcnt vmcnt(13)
    v_mfma_f32_32x32x16_bf16 v[182:197], v[56:59], a[24:27], v[182:197]
    buffer_load_dwordx4 v48, s[24:27], s72 offen offset:2048 lds
    s_add_u32 s72, s72, 196608
    s_sub_u32 s96, s72, 1376256
    s_min_u32 s72, s72, s96
    v_exp_f32 v224, v224
    v_exp_f32 v225, v225
    v_exp_f32 v226, v226
    s_waitcnt vmcnt(13)
    v_mfma_f32_32x32x16_bf16 v[182:197], v[56:59], a[28:31], v[182:197]
    v_exp_f32 v227, v227
    v_exp_f32 v228, v228
    v_exp_f32 v229, v229
    s_waitcnt vmcnt(12)
    v_mfma_f32_32x32x16_bf16 v[182:197], v[56:59], a[32:35], v[182:197]
    s_lshr_b32 s36, s72, 4
    s_add_u32 m0, s36, 67584
    s_nop 0
    buffer_load_dwordx4 v46, s[24:27], s72 offen offset:0 lds
    v_exp_f32 v230, v230
    v_exp_f32 v231, v231
    v_exp_f32 v232, v232
    s_waitcnt vmcnt(12)
    v_mfma_f32_32x32x16_bf16 v[182:197], v[56:59], a[36:39], v[182:197]
    v_exp_f32 v233, v233
    v_exp_f32 v234, v234
    v_exp_f32 v235, v235
    s_waitcnt vmcnt(11)
    v_mfma_f32_32x32x16_bf16 v[182:197], v[56:59], a[40:43], v[182:197]
    v_exp_f32 v236, v236
    v_exp_f32 v237, v237
    v_exp_f32 v198, v198
    s_waitcnt vmcnt(10)
    v_mfma_f32_32x32x16_bf16 v[182:197], v[56:59], a[44:47], v[182:197]
    buffer_load_dwordx4 v47, s[24:27], s72 offen offset:1024 lds
    v_exp_f32 v199, v199
    v_exp_f32 v200, v200
    v_exp_f32 v201, v201
    s_waitcnt vmcnt(10)
    v_mfma_f32_32x32x16_bf16 v[182:197], v[56:59], a[48:51], v[182:197]
    v_exp_f32 v202, v202
    v_exp_f32 v203, v203
    v_exp_f32 v204, v204
    s_waitcnt vmcnt(9)
    v_mfma_f32_32x32x16_bf16 v[182:197], v[56:59], a[52:55], v[182:197]
    v_exp_f32 v205, v205
    v_exp_f32 v206, v206
    v_exp_f32 v207, v207
    s_waitcnt vmcnt(8)
    v_mfma_f32_32x32x16_bf16 v[182:197], v[56:59], a[56:59], v[182:197]
    s_waitcnt vmcnt(6)
    v_readfirstlane_b32 s97, v17
    s_nop 1
    s_cmp_ge_u32 s97, 20
    s_cbranch_scc1 L_pout15
    s_mov_b32 s3, 0
L_poll14:
    v_mov_b32 v17, 0
    s_mov_b64 exec, 1
    buffer_atomic_add v17, off, s[16:19], s1 sc0 sc1
    s_mov_b64 exec, -1
    s_add_u32 s3, s3, 1
    s_waitcnt vmcnt(0)
    s_cmp_gt_u32 s3, 0x40000
    s_cbranch_scc1 L_pout15
    v_readfirstlane_b32 s97, v17
    s_nop 1
    s_cmp_lt_u32 s97, 20
    s_cbranch_scc1 L_poll14
L_pout15:
    buffer_load_dwordx4 a[64:67], v13, s[16:19], s44 offen offset:0 sc1
    v_exp_f32 v208, v208
    v_exp_f32 v209, v209
    v_exp_f32 v210, v210
    v_mfma_f32_32x32x16_bf16 v[182:197], v[56:59], a[60:63], v[182:197]
    v_exp_f32 v211, v211
    v_exp_f32 v212, v212
    v_exp_f32 v213, v213
    v_exp_f32 v214, v214
    v_exp_f32 v215, v215
    v_exp_f32 v216, v216
    v_exp_f32 v217, v217
    v_pk_add_f32 v[8:9], v[218:219], v[220:221]
    v_pk_add_f32 v[8:9], v[8:9], v[222:223]
    v_pk_add_f32 v[8:9], v[8:9], v[224:225]
    v_pk_add_f32 v[8:9], v[8:9], v[226:227]
    buffer_load_dwordx4 a[68:71], v13, s[16:19], s44 offen offset:1024 sc1
    v_pk_add_f32 v[8:9], v[8:9], v[228:229]
    v_pk_add_f32 v[8:9], v[8:9], v[230:231]
    v_pk_add_f32 v[8:9], v[8:9], v[232:233]
    v_pk_add_f32 v[8:9], v[8:9], v[234:235]
    v_pk_add_f32 v[8:9], v[8:9], v[236:237]
    v_add_f32 v8, v8, v9
    v_rcp_f32 v8, v8
    s_nop 0
    v_pk_mul_f32 v[218:219], v[218:219], v[8:9] op_sel_hi:[1,0]
    v_cvt_pk_bf16_f32 v70, v218, v219
    v_cvt_pk_bf16_f32 v182, v182, v183
    v_cvt_pk_bf16_f32 v183, v184, v185
    v_cvt_pk_bf16_f32 v184, v186, v187
    v_cvt_pk_bf16_f32 v185, v188, v189
    s_mov_b32 exec_hi, 0xfffffff
    ds_write_b128 v150, v[182:185]
    s_mov_b32 exec_hi, -1
    buffer_load_dwordx4 a[72:75], v13, s[16:19], s44 offen offset:2048 sc1
    v_pk_mul_f32 v[220:221], v[220:221], v[8:9] op_sel_hi:[1,0]
    v_cvt_pk_bf16_f32 v71, v220, v221
    v_pk_mul_f32 v[222:223], v[222:223], v[8:9] op_sel_hi:[1,0]
    v_cvt_pk_bf16_f32 v72, v222, v223
    v_pk_mul_f32 v[224:225], v[224:225], v[8:9] op_sel_hi:[1,0]
    v_cvt_pk_bf16_f32 v73, v224, v225
    v_pk_mul_f32 v[226:227], v[226:227], v[8:9] op_sel_hi:[1,0]
    v_cvt_pk_bf16_f32 v74, v226, v227
    v_pk_mul_f32 v[228:229], v[228:229], v[8:9] op_sel_hi:[1,0]
    v_cvt_pk_bf16_f32 v75, v228, v229
    v_pk_mul_f32 v[230:231], v[230:231], v[8:9] op_sel_hi:[1,0]
    v_cvt_pk_bf16_f32 v76, v230, v231
    v_pk_mul_f32 v[232:233], v[232:233], v[8:9] op_sel_hi:[1,0]
    v_cvt_pk_bf16_f32 v77, v232, v233
    s_waitcnt lgkmcnt(0)
    s_barrier
    ds_read_b128 v[152:155], v52
    ds_read_b128 v[156:159], v52 offset:768
    ds_read_b64 v[160:161], v53
    ds_read_b128 v[164:167], v54
    ds_read_b128 v[168:171], v54 offset:768
    buffer_load_dwordx4 a[76:79], v13, s[16:19], s44 offen offset:3072 sc1
    ds_read_b64 v[172:173], v55
    v_pk_mul_f32 v[234:235], v[234:235], v[8:9] op_sel_hi:[1,0]
    v_cvt_pk_bf16_f32 v78, v234, v235
    v_pk_mul_f32 v[236:237], v[236:237], v[8:9] op_sel_hi:[1,0]
    v_cvt_pk_bf16_f32 v79, v236, v237
    s_add_u32 s78, s1, 8192
    v_mov_b32 v18, 0
    s_mov_b64 exec, 1
    buffer_atomic_add v18, off, s[16:19], s78 sc0 sc1
    s_mov_b64 exec, -1
    v_pk_add_f32 v[8:9], v[198:199], v[200:201]
    v_pk_add_f32 v[8:9], v[8:9], v[202:203]
    v_pk_add_f32 v[8:9], v[8:9], v[204:205]
    v_pk_add_f32 v[8:9], v[8:9], v[206:207]
    v_pk_add_f32 v[8:9], v[8:9], v[208:209]
    v_pk_add_f32 v[8:9], v[8:9], v[210:211]
    v_pk_add_f32 v[8:9], v[8:9], v[212:213]
    v_pk_add_f32 v[8:9], v[8:9], v[214:215]
    v_pk_add_f32 v[8:9], v[8:9], v[216:217]
    v_add_f32 v8, v8, v9
    v_rcp_f32 v8, v8
    s_nop 0
    v_pk_mul_f32 v[198:199], v[198:199], v[8:9] op_sel_hi:[1,0]
    s_add_u32 s38, s44, 4096
    buffer_load_dwordx4 a[80:83], v13, s[16:19], s38 offen offset:0 sc1
    v_cvt_pk_bf16_f32 v80, v198, v199
    v_pk_mul_f32 v[200:201], v[200:201], v[8:9] op_sel_hi:[1,0]
    v_cvt_pk_bf16_f32 v81, v200, v201
    v_pk_mul_f32 v[202:203], v[202:203], v[8:9] op_sel_hi:[1,0]
    v_cvt_pk_bf16_f32 v82, v202, v203
    v_pk_mul_f32 v[204:205], v[204:205], v[8:9] op_sel_hi:[1,0]
    v_cvt_pk_bf16_f32 v83, v204, v205
    v_pk_mul_f32 v[206:207], v[206:207], v[8:9] op_sel_hi:[1,0]
    v_cvt_pk_bf16_f32 v84, v206, v207
    v_pk_mul_f32 v[208:209], v[208:209], v[8:9] op_sel_hi:[1,0]
    v_cvt_pk_bf16_f32 v85, v208, v209
    v_pk_mul_f32 v[210:211], v[210:211], v[8:9] op_sel_hi:[1,0]
    v_cvt_pk_bf16_f32 v86, v210, v211
    v_pk_mul_f32 v[212:213], v[212:213], v[8:9] op_sel_hi:[1,0]
    v_cvt_pk_bf16_f32 v87, v212, v213
    v_pk_mul_f32 v[214:215], v[214:215], v[8:9] op_sel_hi:[1,0]
    v_cvt_pk_bf16_f32 v88, v214, v215
    v_pk_mul_f32 v[216:217], v[216:217], v[8:9] op_sel_hi:[1,0]
    v_cvt_pk_bf16_f32 v89, v216, v217
    v_permlane32_swap_b32 v70, v80
    v_permlane32_swap_b32 v71, v81
    v_permlane32_swap_b32 v72, v82
    v_permlane32_swap_b32 v73, v83
    v_permlane32_swap_b32 v74, v84
    s_waitcnt lgkmcnt(5)
    v_mfma_f32_32x32x16_bf16 v[102:117], v[152:155], v[70:73], 0
    v_permlane32_swap_b32 v75, v85
    v_permlane32_swap_b32 v76, v86
    v_permlane32_swap_b32 v77, v87
    s_waitcnt lgkmcnt(2)
    v_mfma_f32_32x32x16_bf16 v[118:133], v[164:167], v[80:83], 0
    v_permlane32_swap_b32 v78, v88
    v_permlane32_swap_b32 v79, v89
    v_mfma_f32_32x32x16_bf16 v[102:117], v[160:163], v[74:77], v[102:117]
    s_nop 0
    v_mfma_f32_32x32x16_bf16 v[102:117], v[156:159], v[76:79], v[102:117]
    s_waitcnt lgkmcnt(0)
    v_mfma_f32_32x32x16_bf16 v[118:133], v[172:175], v[84:87], v[118:133]
    v_mfma_f32_32x32x16_bf16 v[118:133], v[168:171], v[86:89], v[118:133]
    s_nop 8
    v_add_f32 v114, 0x358637bd, v114
    v_rcp_f32 v114, v114
    s_nop 0
    v_pk_mul_f32 v[102:103], v[102:103], v[114:115] op_sel_hi:[1,0]
    v_pk_mul_f32 v[104:105], v[104:105], v[114:115] op_sel_hi:[1,0]
    v_pk_mul_f32 v[106:107], v[106:107], v[114:115] op_sel_hi:[1,0]
    v_pk_mul_f32 v[108:109], v[108:109], v[114:115] op_sel_hi:[1,0]
    v_pk_mul_f32 v[110:111], v[110:111], v[114:115] op_sel_hi:[1,0]
    v_pk_mul_f32 v[112:113], v[112:113], v[114:115] op_sel_hi:[1,0]
    v_cvt_pk_bf16_f32 v152, v102, v103
    v_cvt_pk_bf16_f32 v153, v104, v105
    v_cvt_pk_bf16_f32 v154, v106, v107
    v_cvt_pk_bf16_f32 v155, v108, v109
    buffer_store_dwordx4 v[152:155], v23, s[16:19], s22 offen offset:0 sc1
    v_cvt_pk_bf16_f32 v160, v110, v111
    v_cvt_pk_bf16_f32 v161, v112, v113
    v_add_f32 v130, 0x358637bd, v130
    v_rcp_f32 v130, v130
    s_nop 0
    v_pk_mul_f32 v[118:119], v[118:119], v[130:131] op_sel_hi:[1,0]
    v_pk_mul_f32 v[120:121], v[120:121], v[130:131] op_sel_hi:[1,0]
    v_pk_mul_f32 v[122:123], v[122:123], v[130:131] op_sel_hi:[1,0]
    v_pk_mul_f32 v[124:125], v[124:125], v[130:131] op_sel_hi:[1,0]
    v_pk_mul_f32 v[126:127], v[126:127], v[130:131] op_sel_hi:[1,0]
    v_pk_mul_f32 v[128:129], v[128:129], v[130:131] op_sel_hi:[1,0]
    v_cvt_pk_bf16_f32 v156, v118, v119
    v_cvt_pk_bf16_f32 v157, v120, v121
    v_cvt_pk_bf16_f32 v158, v122, v123
    v_cvt_pk_bf16_f32 v159, v124, v125
    buffer_store_dwordx4 v[156:159], v23, s[16:19], s22 offen offset:768 sc1
    v_cvt_pk_bf16_f32 v162, v126, v127
    v_cvt_pk_bf16_f32 v163, v128, v129
    s_mov_b32 exec_hi, 0
    buffer_store_dwordx4 v[160:163], v23, s[16:19], s22 offen offset:512 sc1
    s_mov_b32 exec_hi, -1
    s_lshl_b32 s94, s58, 2
    s_add_u32 s94, s94, s52
    s_lshl_b32 s59, s55, 3
    s_add_u32 s95, s94, s59
    s_mul_i32 s59, s95, 20480
    s_mul_i32 m0, s52, 2560
    s_nop 0
    buffer_load_dwordx4 v49, s[8:11], s59 offen offset:0 lds
    buffer_load_dwordx4 v50, s[8:11], s59 offen offset:1024 lds
    s_mov_b32 exec_hi, 0
    buffer_load_dwordx4 v51, s[8:11], s59 offen offset:2048 lds
    s_mov_b32 exec_hi, -1
    s_waitcnt vmcnt(7)
    v_mov_b32 v17, v18
    s_nop 0
    v_readfirstlane_b32 s97, v17
    s_nop 1
    s_cmp_ge_u32 s97, 40
    s_cbranch_scc1 L_pout17
    s_mov_b32 s3, 0
L_poll16:
    v_mov_b32 v17, 0
    s_mov_b64 exec, 1
    buffer_atomic_add v17, off, s[16:19], s78 sc0 sc1
    s_mov_b64 exec, -1
    s_add_u32 s3, s3, 1
    s_waitcnt vmcnt(0)
    s_cmp_gt_u32 s3, 0x40000
    s_cbranch_scc1 L_pout17
    v_readfirstlane_b32 s97, v17
    s_nop 1
    s_cmp_lt_u32 s97, 40
    s_cbranch_scc1 L_poll16
L_pout17:
    s_mul_i32 s79, s57, 68
    s_mul_i32 s60, s52, 12
    s_add_u32 s79, s79, s60
    s_mul_i32 s79, s79, 5120
    s_add_u32 s79, s79, 16879616
    s_and_b32 s62, s2, 7
    s_lshl_b32 s62, s62, 2
    s_lshr_b32 s62, 0x32103210, s62
    s_and_b32 s62, s62, 7
    s_mul_i32 s62, s62, 15360
    s_add_u32 s4, s79, s62
    s_add_u32 s62, s62, 15360
    s_sub_u32 s63, s62, 61440
    s_min_u32 s62, s62, s63
    s_add_u32 s5, s79, s62
    s_add_u32 s62, s62, 15360
    s_sub_u32 s63, s62, 61440
    s_min_u32 s62, s62, s63
    s_add_u32 s6, s79, s62
    s_add_u32 s62, s62, 15360
    s_sub_u32 s63, s62, 61440
    s_min_u32 s62, s62, s63
    s_add_u32 s7, s79, s62
    buffer_load_dwordx4 a[84:87], v13, s[16:19], s45 offen offset:0 sc1
    buffer_load_dwordx4 a[88:91], v13, s[16:19], s45 offen offset:1024 sc1
    buffer_load_dwordx4 a[92:95], v13, s[16:19], s45 offen offset:2048 sc1
    buffer_load_dwordx4 a[96:99], v13, s[16:19], s45 offen offset:3072 sc1
    s_add_u32 s38, s45, 4096
    buffer_load_dwordx4 a[100:103], v13, s[16:19], s38 offen offset:0 sc1
    s_lshl_b32 s59, s53, 1
    s_add_u32 s59, s59, s99
    s_lshl_b32 s59, s59, 2
    s_lshr_b32 s60, s54, 2
    s_add_u32 s59, s59, s60
    s_lshl_b32 s59, s59, 7
    s_add_u32 s59, s59, 4096
    v_lshrrev_b32 v6, 4, v1
    v_and_b32 v7, 15, v1
    s_xor_b32 s60, s52, 0
    s_mul_i32 s61, s60, 20480
    s_mul_i32 s60, s60, 15360
    v_add_u32 v50, s61, v13
    v_add_u32 v54, s60, v13
    s_xor_b32 s60, s52, 1
    s_mul_i32 s61, s60, 20480
    s_mul_i32 s60, s60, 15360
    v_add_u32 v51, s61, v13
    v_add_u32 v55, s60, v13
    s_xor_b32 s60, s52, 2
    s_mul_i32 s61, s60, 20480
    s_mul_i32 s60, s60, 15360
    v_add_u32 v52, s61, v13
    v_add_u32 v56, s60, v13
    s_xor_b32 s60, s52, 3
    s_mul_i32 s61, s60, 20480
    s_mul_i32 s60, s60, 15360
    v_add_u32 v53, s61, v13
    v_add_u32 v57, s60, v13
    s_waitcnt vmcnt(8)
    s_mov_b64 exec, 1
    buffer_atomic_add v15, off, s[16:19], s59 sc1
    s_mov_b64 exec, -1
    buffer_load_dwordx4 a[104:107], v13, s[16:19], s46 offen offset:0 sc1
    buffer_load_dwordx4 a[108:111], v13, s[16:19], s46 offen offset:1024 sc1
    buffer_load_dwordx4 a[112:115], v13, s[16:19], s46 offen offset:2048 sc1
    buffer_load_dwordx4 a[116:119], v13, s[16:19], s46 offen offset:3072 sc1
    s_add_u32 s38, s46, 4096
    buffer_load_dwordx4 a[120:123], v13, s[16:19], s38 offen offset:0 sc1
    buffer_load_dwordx4 a[124:127], v13, s[16:19], s47 offen offset:0 sc1
    buffer_load_dwordx4 a[128:131], v13, s[16:19], s47 offen offset:1024 sc1
    s_mul_i32 s60, s52, 2560
    v_mul_u32_u24 v2, 160, v7
    v_lshl_add_u32 v2, v6, 3, v2
    v_add_u32 v2, s60, v2
    s_waitcnt vmcnt(13)
    ds_read_b64 v[196:197], v2 offset:0
    ds_read_b64 v[198:199], v2 offset:32
    ds_read_b64 v[200:201], v2 offset:64
    ds_read_b64 v[202:203], v2 offset:96
    ds_read_b64 v[204:205], v2 offset:128
    v_bfe_u32 v2, v1, 4, 1
    v_lshl_add_u32 v8, v2, 1, v19
    v_lshlrev_b32 v9, 9, v8
    v_lshl_add_u32 v9, v7, 4, v9
    s_lshr_b32 s74, s95, 1
    s_lshl3_add_u32 s74, s74, s57
    s_mul_i32 s74, s74, 5120
    s_lshl_b32 s60, s98, 8
    s_add_u32 s74, s74, s60
    s_add_u32 s74, s74, 5242880
    s_add_u32 s75, s74, 4096
    s_lshl_b32 s78, s95, 3
    s_add_u32 s78, s78, s57
    s_lshl_b32 s78, s78, 7
    s_add_u32 s78, s78, 8388608
    s_and_b32 s59, s95, -4
    s_lshl2_add_u32 s59, s59, s52
    s_mul_i32 s59, s59, 5120
    s_add_u32 s59, s59, 2097152
    s_and_b32 s62, s2, 7
    s_lshl_b32 s62, s62, 2
    s_lshr_b32 s62, 0x42043210, s62
    s_and_b32 s62, s62, 7
    s_mul_i32 s62, s62, 1024
    s_add_u32 s80, s59, s62
    s_add_u32 s62, s62, 1024
    s_sub_u32 s63, s62, 5120
    s_min_u32 s62, s62, s63
    s_add_u32 s81, s59, s62
    s_add_u32 s62, s62, 1024
    s_sub_u32 s63, s62, 5120
    s_min_u32 s62, s62, s63
    s_add_u32 s82, s59, s62
    s_add_u32 s62, s62, 1024
    s_sub_u32 s63, s62, 5120
    s_min_u32 s62, s62, s63
    s_add_u32 s83, s59, s62
    s_add_u32 s62, s62, 1024
    s_sub_u32 s63, s62, 5120
    s_min_u32 s62, s62, s63
    s_add_u32 s84, s59, s62
    s_lshl_b32 s60, s95, 7
    s_add_u32 s60, s60, 4096
    v_mov_b32 v17, 0
    s_mov_b64 exec, 1
    buffer_atomic_add v17, off, s[16:19], s60 sc0 sc1
    s_mov_b64 exec, -1
    buffer_load_dwordx4 a[132:135], v13, s[16:19], s47 offen offset:2048 sc1
    buffer_load_dwordx4 a[136:139], v13, s[16:19], s47 offen offset:3072 sc1
    s_add_u32 s38, s47, 4096
    buffer_load_dwordx4 a[140:143], v13, s[16:19], s38 offen offset:0 sc1
    buffer_load_dwordx4 a[144:147], v13, s[16:19], s48 offen offset:0 sc1
    buffer_load_dwordx4 a[148:151], v13, s[16:19], s48 offen offset:1024 sc1
    buffer_load_dwordx4 a[152:155], v13, s[16:19], s48 offen offset:2048 sc1
    buffer_load_dwordx4 a[156:159], v13, s[16:19], s48 offen offset:3072 sc1
    s_add_u32 s38, s48, 4096
    buffer_load_dwordx4 a[160:163], v13, s[16:19], s38 offen offset:0 sc1
    s_waitcnt lgkmcnt(4)
    v_lshlrev_b32 v176, 16, v196
    v_and_b32 v177, 0xffff0000, v196
    v_lshlrev_b32 v178, 16, v197
    v_and_b32 v179, 0xffff0000, v197
    s_waitcnt lgkmcnt(3)
    v_lshlrev_b32 v180, 16, v198
    v_and_b32 v181, 0xffff0000, v198
    v_lshlrev_b32 v182, 16, v199
    v_and_b32 v183, 0xffff0000, v199
    s_waitcnt lgkmcnt(2)
    v_lshlrev_b32 v184, 16, v200
    v_and_b32 v185, 0xffff0000, v200
    v_lshlrev_b32 v186, 16, v201
    v_and_b32 v187, 0xffff0000, v201
    s_waitcnt lgkmcnt(1)
    v_lshlrev_b32 v188, 16, v202
    v_and_b32 v189, 0xffff0000, v202
    v_lshlrev_b32 v190, 16, v203
    v_and_b32 v191, 0xffff0000, v203
    s_waitcnt lgkmcnt(0)
    v_lshlrev_b32 v192, 16, v204
    v_and_b32 v193, 0xffff0000, v204
    v_lshlrev_b32 v194, 16, v205
    v_and_b32 v195, 0xffff0000, v205
    s_barrier
    s_waitcnt vmcnt(8)
    v_readfirstlane_b32 s97, v17
    s_nop 1
    s_cmp_ge_u32 s97, 8
    s_cbranch_scc1 L_pout19
    s_mov_b32 s3, 0
L_poll18:
    v_mov_b32 v17, 0
    s_mov_b64 exec, 1
    buffer_atomic_add v17, off, s[16:19], s60 sc0 sc1
    s_mov_b64 exec, -1
    s_add_u32 s3, s3, 1
    s_waitcnt vmcnt(0)
    s_cmp_gt_u32 s3, 0x40000
    s_cbranch_scc1 L_pout19
    v_readfirstlane_b32 s97, v17
    s_nop 1
    s_cmp_lt_u32 s97, 8
    s_cbranch_scc1 L_poll18
L_pout19:
    buffer_load_dwordx4 v[60:63], v51, s[16:19], s80 offen offset:0 sc1
    buffer_load_dwordx4 v[64:67], v51, s[16:19], s81 offen offset:0 sc1
    buffer_load_dwordx4 v[68:71], v51, s[16:19], s82 offen offset:0 sc1
L_pad3:
    s_cbranch_execz L_padret
    buffer_load_dwordx4 v[72:75], v51, s[16:19], s83 offen offset:0 sc1
    buffer_load_dwordx4 v[76:79], v51, s[16:19], s84 offen offset:0 sc1
    buffer_load_dwordx4 v[80:83], v52, s[16:19], s80 offen offset:0 sc1
    buffer_load_dwordx4 v[84:87], v52, s[16:19], s81 offen offset:0 sc1
    buffer_load_dwordx4 v[88:91], v52, s[16:19], s82 offen offset:0 sc1
    s_waitcnt vmcnt(7)
    v_mfma_f32_16x16x32_bf16 v[196:199], a[64:67], v[60:63], 0
    buffer_load_dwordx4 v[92:95], v52, s[16:19], s83 offen offset:0 sc1
    v_mfma_f32_16x16x32_bf16 v[200:203], a[68:71], v[60:63], 0
    v_mfma_f32_16x16x32_bf16 v[204:207], a[72:75], v[60:63], 0
    v_mfma_f32_16x16x32_bf16 v[208:211], a[76:79], v[60:63], 0
    v_mfma_f32_16x16x32_bf16 v[212:215], a[80:83], v[60:63], 0
    s_waitcnt vmcnt(7)
    v_mfma_f32_16x16x32_bf16 v[196:199], a[84:87], v[64:67], v[196:199]
    buffer_load_dwordx4 v[96:99], v52, s[16:19], s84 offen offset:0 sc1
    v_mfma_f32_16x16x32_bf16 v[200:203], a[88:91], v[64:67], v[200:203]
    v_mfma_f32_16x16x32_bf16 v[204:207], a[92:95], v[64:67], v[204:207]
    v_mfma_f32_16x16x32_bf16 v[208:211], a[96:99], v[64:67], v[208:211]
    v_mfma_f32_16x16x32_bf16 v[212:215], a[100:103], v[64:67], v[212:215]
    s_waitcnt vmcnt(7)
    v_mfma_f32_16x16x32_bf16 v[196:199], a[104:107], v[68:71], v[196:199]
    buffer_load_dwordx4 v[100:103], v53, s[16:19], s80 offen offset:0 sc1
    v_mfma_f32_16x16x32_bf16 v[200:203], a[108:111], v[68:71], v[200:203]
    v_mfma_f32_16x16x32_bf16 v[204:207], a[112:115], v[68:71], v[204:207]
    v_mfma_f32_16x16x32_bf16 v[208:211], a[116:119], v[68:71], v[208:211]
    v_mfma_f32_16x16x32_bf16 v[212:215], a[120:123], v[68:71], v[212:215]
    s_waitcnt vmcnt(7)
    v_mfma_f32_16x16x32_bf16 v[196:199], a[124:127], v[72:75], v[196:199]
    buffer_load_dwordx4 v[104:107], v53, s[16:19], s81 offen offset:0 sc1
    v_mfma_f32_16x16x32_bf16 v[200:203], a[128:131], v[72:75], v[200:203]
    v_mfma_f32_16x16x32_bf16 v[204:207], a[132:135], v[72:75], v[204:207]
    v_mfma_f32_16x16x32_bf16 v[208:211], a[136:139], v[72:75], v[208:211]
    v_mfma_f32_16x16x32_bf16 v[212:215], a[140:143], v[72:75], v[212:215]
    s_waitcnt vmcnt(7)
    v_mfma_f32_16x16x32_bf16 v[196:199], a[144:147], v[76:79], v[196:199]
    buffer_load_dwordx4 v[108:111], v53, s[16:19], s82 offen offset:0 sc1
    v_mfma_f32_16x16x32_bf16 v[200:203], a[148:151], v[76:79], v[200:203]
    v_mfma_f32_16x16x32_bf16 v[204:207], a[152:155], v[76:79], v[204:207]
    v_mfma_f32_16x16x32_bf16 v[208:211], a[156:159], v[76:79], v[208:211]
    v_mfma_f32_16x16x32_bf16 v[212:215], a[160:163], v[76:79], v[212:215]
    s_waitcnt vmcnt(7)
    v_mfma_f32_16x16x32_bf16 v[216:219], a[64:67], v[80:83], 0
    buffer_load_dwordx4 v[112:115], v53, s[16:19], s83 offen offset:0 sc1
    v_mfma_f32_16x16x32_bf16 v[220:223], a[68:71], v[80:83], 0
    v_mfma_f32_16x16x32_bf16 v[224:227], a[72:75], v[80:83], 0
    ds_write_b128 v55, v[196:199] offset:0
    v_mfma_f32_16x16x32_bf16 v[228:231], a[76:79], v[80:83], 0
    v_mfma_f32_16x16x32_bf16 v[232:235], a[80:83], v[80:83], 0
    s_waitcnt vmcnt(7)
    v_mfma_f32_16x16x32_bf16 v[216:219], a[84:87], v[84:87], v[216:219]
    buffer_load_dwordx4 v[116:119], v53, s[16:19], s84 offen offset:0 sc1
    ds_write_b128 v55, v[200:203] offset:1024
    v_mfma_f32_16x16x32_bf16 v[220:223], a[88:91], v[84:87], v[220:223]
    v_mfma_f32_16x16x32_bf16 v[224:227], a[92:95], v[84:87], v[224:227]
    v_mfma_f32_16x16x32_bf16 v[228:231], a[96:99], v[84:87], v[228:231]
    ds_write_b128 v55, v[204:207] offset:2048
    v_mfma_f32_16x16x32_bf16 v[232:235], a[100:103], v[84:87], v[232:235]
    s_waitcnt vmcnt(7)
    v_mfma_f32_16x16x32_bf16 v[216:219], a[104:107], v[88:91], v[216:219]
    buffer_load_dwordx4 v[120:123], v50, s[16:19], s80 offen offset:0 sc1
    v_mfma_f32_16x16x32_bf16 v[220:223], a[108:111], v[88:91], v[220:223]
    ds_write_b128 v55, v[208:211] offset:3072
    v_mfma_f32_16x16x32_bf16 v[224:227], a[112:115], v[88:91], v[224:227]
    v_mfma_f32_16x16x32_bf16 v[228:231], a[116:119], v[88:91], v[228:231]
    v_mfma_f32_16x16x32_bf16 v[232:235], a[120:123], v[88:91], v[232:235]
    ds_write_b128 v55, v[212:215] offset:4096
    s_waitcnt vmcnt(7)
    v_mfma_f32_16x16x32_bf16 v[216:219], a[124:127], v[92:95], v[216:219]
    buffer_load_dwordx4 v[60:63], v50, s[16:19], s81 offen offset:0 sc1
    v_mfma_f32_16x16x32_bf16 v[220:223], a[128:131], v[92:95], v[220:223]
    v_mfma_f32_16x16x32_bf16 v[224:227], a[132:135], v[92:95], v[224:227]
    v_mfma_f32_16x16x32_bf16 v[228:231], a[136:139], v[92:95], v[228:231]
    v_mfma_f32_16x16x32_bf16 v[232:235], a[140:143], v[92:95], v[232:235]
    s_waitcnt vmcnt(7)
    v_mfma_f32_16x16x32_bf16 v[216:219], a[144:147], v[96:99], v[216:219]
    buffer_load_dwordx4 v[64:67], v50, s[16:19], s82 offen offset:0 sc1
    v_mfma_f32_16x16x32_bf16 v[220:223], a[148:151], v[96:99], v[220:223]
    v_mfma_f32_16x16x32_bf16 v[224:227], a[152:155], v[96:99], v[224:227]
    v_mfma_f32_16x16x32_bf16 v[228:231], a[156:159], v[96:99], v[228:231]
    v_mfma_f32_16x16x32_bf16 v[232:235], a[160:163], v[96:99], v[232:235]
    s_waitcnt vmcnt(7)
    v_mfma_f32_16x16x32_bf16 v[236:239], a[64:67], v[100:103], 0
    buffer_load_dwordx4 v[68:71], v50, s[16:19], s83 offen offset:0 sc1
    v_mfma_f32_16x16x32_bf16 v[240:243], a[68:71], v[100:103], 0
    v_mfma_f32_16x16x32_bf16 v[244:247], a[72:75], v[100:103], 0
    ds_write_b128 v56, v[216:219] offset:5120
    v_mfma_f32_16x16x32_bf16 v[248:251], a[76:79], v[100:103], 0
    v_mfma_f32_16x16x32_bf16 v[252:255], a[80:83], v[100:103], 0
    s_waitcnt vmcnt(7)
    v_mfma_f32_16x16x32_bf16 v[236:239], a[84:87], v[104:107], v[236:239]
    buffer_load_dwordx4 v[72:75], v50, s[16:19], s84 offen offset:0 sc1
    ds_write_b128 v56, v[220:223] offset:6144
    v_mfma_f32_16x16x32_bf16 v[240:243], a[88:91], v[104:107], v[240:243]
    v_mfma_f32_16x16x32_bf16 v[244:247], a[92:95], v[104:107], v[244:247]
    v_mfma_f32_16x16x32_bf16 v[248:251], a[96:99], v[104:107], v[248:251]
    ds_write_b128 v56, v[224:227] offset:7168
    v_mfma_f32_16x16x32_bf16 v[252:255], a[100:103], v[104:107], v[252:255]
    s_waitcnt vmcnt(7)
    v_mfma_f32_16x16x32_bf16 v[236:239], a[104:107], v[108:111], v[236:239]
    s_add_u32 m0, s36, 67584
    s_nop 0
    buffer_load_dwordx4 v48, s[24:27], s72 offen offset:2048 lds
    v_mfma_f32_16x16x32_bf16 v[240:243], a[108:111], v[108:111], v[240:243]
    ds_write_b128 v56, v[228:231] offset:8192
    v_mfma_f32_16x16x32_bf16 v[244:247], a[112:115], v[108:111], v[244:247]
    v_mfma_f32_16x16x32_bf16 v[248:251], a[116:119], v[108:111], v[248:251]
    v_mfma_f32_16x16x32_bf16 v[252:255], a[120:123], v[108:111], v[252:255]
    ds_write_b128 v56, v[232:235] offset:9216
    s_waitcnt vmcnt(7)
    v_mfma_f32_16x16x32_bf16 v[236:239], a[124:127], v[112:115], v[236:239]
    buffer_load_dwordx4 a[164:167], v13, s[16:19], s4 offen offset:0 sc1
    v_mfma_f32_16x16x32_bf16 v[240:243], a[128:131], v[112:115], v[240:243]
    v_mfma_f32_16x16x32_bf16 v[244:247], a[132:135], v[112:115], v[244:247]
    v_mfma_f32_16x16x32_bf16 v[248:251], a[136:139], v[112:115], v[248:251]
    v_mfma_f32_16x16x32_bf16 v[252:255], a[140:143], v[112:115], v[252:255]
    s_waitcnt lgkmcnt(0)
    s_barrier
    s_waitcnt vmcnt(7)
    v_mfma_f32_16x16x32_bf16 v[236:239], a[144:147], v[116:119], v[236:239]
    buffer_load_dwordx4 a[168:171], v13, s[16:19], s4 offen offset:1024 sc1
    ds_read_b128 v[196:199], v54 offset:0
    ds_read_b128 v[200:203], v54 offset:1024
    v_mfma_f32_16x16x32_bf16 v[240:243], a[148:151], v[116:119], v[240:243]
    ds_read_b128 v[204:207], v54 offset:2048
    ds_read_b128 v[208:211], v54 offset:3072
    v_mfma_f32_16x16x32_bf16 v[244:247], a[152:155], v[116:119], v[244:247]
    ds_read_b128 v[212:215], v54 offset:4096
    ds_read_b128 v[216:219], v54 offset:5120
    v_mfma_f32_16x16x32_bf16 v[248:251], a[156:159], v[116:119], v[248:251]
    ds_read_b128 v[220:223], v54 offset:6144
    ds_read_b128 v[224:227], v54 offset:7168
    v_mfma_f32_16x16x32_bf16 v[252:255], a[160:163], v[116:119], v[252:255]
    ds_read_b128 v[228:231], v54 offset:8192
    ds_read_b128 v[232:235], v54 offset:9216
    s_waitcnt vmcnt(7)
    v_mfma_f32_16x16x32_bf16 v[176:179], a[64:67], v[120:123], v[176:179]
    buffer_load_dwordx4 a[172:175], v13, s[16:19], s4 offen offset:2048 sc1
    v_mfma_f32_16x16x32_bf16 v[180:183], a[68:71], v[120:123], v[180:183]
    v_mfma_f32_16x16x32_bf16 v[184:187], a[72:75], v[120:123], v[184:187]
    ds_write_b128 v57, v[236:239] offset:10240
    v_mfma_f32_16x16x32_bf16 v[188:191], a[76:79], v[120:123], v[188:191]
    s_waitcnt lgkmcnt(5)
    v_add_f32 v196, v196, v216
    v_add_f32 v197, v197, v217
    v_mfma_f32_16x16x32_bf16 v[192:195], a[80:83], v[120:123], v[192:195]
    v_add_f32 v198, v198, v218
    v_add_f32 v199, v199, v219
    s_waitcnt vmcnt(7)
    v_mfma_f32_16x16x32_bf16 v[176:179], a[84:87], v[60:63], v[176:179]
    buffer_load_dwordx4 a[176:179], v13, s[16:19], s4 offen offset:3072 sc1
    ds_write_b128 v57, v[240:243] offset:11264
    v_mfma_f32_16x16x32_bf16 v[180:183], a[88:91], v[60:63], v[180:183]
    s_waitcnt lgkmcnt(5)
    v_add_f32 v200, v200, v220
    v_add_f32 v201, v201, v221
    v_mfma_f32_16x16x32_bf16 v[184:187], a[92:95], v[60:63], v[184:187]
    v_add_f32 v202, v202, v222
    v_add_f32 v203, v203, v223
    v_mfma_f32_16x16x32_bf16 v[188:191], a[96:99], v[60:63], v[188:191]
    ds_write_b128 v57, v[244:247] offset:12288
    v_mfma_f32_16x16x32_bf16 v[192:195], a[100:103], v[60:63], v[192:195]
    s_waitcnt lgkmcnt(5)
    v_add_f32 v204, v204, v224
    v_add_f32 v205, v205, v225
    s_waitcnt vmcnt(7)
    v_mfma_f32_16x16x32_bf16 v[176:179], a[104:107], v[64:67], v[176:179]
    s_add_u32 s38, s4, 4096
    buffer_load_dwordx4 a[180:183], v13, s[16:19], s38 offen offset:0 sc1
    v_add_f32 v206, v206, v226
    v_add_f32 v207, v207, v227
    v_mfma_f32_16x16x32_bf16 v[180:183], a[108:111], v[64:67], v[180:183]
    ds_write_b128 v57, v[248:251] offset:13312
    v_mfma_f32_16x16x32_bf16 v[184:187], a[112:115], v[64:67], v[184:187]
    s_waitcnt lgkmcnt(5)
    v_add_f32 v208, v208, v228
    v_add_f32 v209, v209, v229
    v_mfma_f32_16x16x32_bf16 v[188:191], a[116:119], v[64:67], v[188:191]
    v_add_f32 v210, v210, v230
    v_add_f32 v211, v211, v231
    v_mfma_f32_16x16x32_bf16 v[192:195], a[120:123], v[64:67], v[192:195]
    ds_write_b128 v57, v[252:255] offset:14336
    s_waitcnt vmcnt(7)
    v_mfma_f32_16x16x32_bf16 v[176:179], a[124:127], v[68:71], v[176:179]
    buffer_load_dwordx4 a[184:187], v13, s[16:19], s5 offen offset:0 sc1
    s_waitcnt lgkmcnt(5)
    v_add_f32 v212, v212, v232
    v_add_f32 v213, v213, v233
    v_mfma_f32_16x16x32_bf16 v[180:183], a[128:131], v[68:71], v[180:183]
    v_add_f32 v214, v214, v234
    v_add_f32 v215, v215, v235
    v_mfma_f32_16x16x32_bf16 v[184:187], a[132:135], v[68:71], v[184:187]
    v_mfma_f32_16x16x32_bf16 v[188:191], a[136:139], v[68:71], v[188:191]
    s_waitcnt lgkmcnt(0)
    s_barrier
    v_mfma_f32_16x16x32_bf16 v[192:195], a[140:143], v[68:71], v[192:195]
    ds_read_b128 v[236:239], v54 offset:10240
    ds_read_b128 v[240:243], v54 offset:11264
    s_waitcnt vmcnt(7)
    v_mfma_f32_16x16x32_bf16 v[176:179], a[144:147], v[72:75], v[176:179]
    buffer_load_dwordx4 a[188:191], v13, s[16:19], s5 offen offset:1024 sc1
    ds_read_b128 v[244:247], v54 offset:12288
    ds_read_b128 v[248:251], v54 offset:13312
    v_mfma_f32_16x16x32_bf16 v[180:183], a[148:151], v[72:75], v[180:183]
    ds_read_b128 v[252:255], v54 offset:14336
    v_mfma_f32_16x16x32_bf16 v[184:187], a[152:155], v[72:75], v[184:187]
    v_mfma_f32_16x16x32_bf16 v[188:191], a[156:159], v[72:75], v[188:191]
    v_mfma_f32_16x16x32_bf16 v[192:195], a[160:163], v[72:75], v[192:195]
    v_pk_add_f32 v[176:177], v[176:177], v[196:197]
    s_waitcnt lgkmcnt(4)
    v_pk_add_f32 v[176:177], v[176:177], v[236:237]
    v_cvt_pk_bf16_f32 v60, v176, v177
    v_cvt_pk_bf16_f32 v196, v176, v177
    v_pk_add_f32 v[178:179], v[178:179], v[198:199]
    v_pk_add_f32 v[178:179], v[178:179], v[238:239]
    v_cvt_pk_bf16_f32 v61, v178, v179
    v_cvt_pk_bf16_f32 v198, v178, v179
    v_pk_add_f32 v[180:181], v[180:181], v[200:201]
    s_waitcnt lgkmcnt(3)
    v_pk_add_f32 v[180:181], v[180:181], v[240:241]
    v_cvt_pk_bf16_f32 v62, v180, v181
    v_cvt_pk_bf16_f32 v200, v180, v181
    v_pk_add_f32 v[182:183], v[182:183], v[202:203]
    v_pk_add_f32 v[182:183], v[182:183], v[242:243]
    v_cvt_pk_bf16_f32 v63, v182, v183
    v_cvt_pk_bf16_f32 v202, v182, v183
    v_pk_add_f32 v[184:185], v[184:185], v[204:205]
    s_waitcnt lgkmcnt(2)
    v_pk_add_f32 v[184:185], v[184:185], v[244:245]
    v_cvt_pk_bf16_f32 v64, v184, v185
    v_cvt_pk_bf16_f32 v204, v184, v185
    v_permlane16_swap_b32 v60, v62
    v_permlane16_swap_b32 v61, v63
    buffer_store_dwordx4 v[60:63], v9, s[16:19], s74 offen offset:0 sc1
    v_pk_add_f32 v[186:187], v[186:187], v[206:207]
    v_pk_add_f32 v[186:187], v[186:187], v[246:247]
    v_cvt_pk_bf16_f32 v65, v186, v187
    v_cvt_pk_bf16_f32 v206, v186, v187
    v_pk_add_f32 v[188:189], v[188:189], v[208:209]
    s_waitcnt lgkmcnt(1)
    v_pk_add_f32 v[188:189], v[188:189], v[248:249]
    v_cvt_pk_bf16_f32 v66, v188, v189
    v_cvt_pk_bf16_f32 v208, v188, v189
    v_pk_add_f32 v[190:191], v[190:191], v[210:211]
    v_pk_add_f32 v[190:191], v[190:191], v[250:251]
    v_cvt_pk_bf16_f32 v67, v190, v191
    v_cvt_pk_bf16_f32 v210, v190, v191
    v_pk_add_f32 v[192:193], v[192:193], v[212:213]
    s_waitcnt lgkmcnt(0)
    v_pk_add_f32 v[192:193], v[192:193], v[252:253]
    v_cvt_pk_bf16_f32 v68, v192, v193
    v_cvt_pk_bf16_f32 v212, v192, v193
    v_mov_b32 v70, v68
    v_permlane16_swap_b32 v64, v66
    v_permlane16_swap_b32 v65, v67
    buffer_store_dwordx4 v[64:67], v9, s[16:19], s74 offen offset:2048 sc1
    v_pk_add_f32 v[194:195], v[194:195], v[214:215]
    v_pk_add_f32 v[194:195], v[194:195], v[254:255]
    v_cvt_pk_bf16_f32 v69, v194, v195
    v_cvt_pk_bf16_f32 v214, v194, v195
    v_mov_b32 v71, v69
    v_permlane16_swap_b32 v68, v70
    s_nop 0
    v_permlane16_swap_b32 v69, v71
    s_mov_b32 exec_lo, 0xffff
    s_mov_b32 exec_hi, 0xffff
    buffer_store_dwordx4 v[68:71], v9, s[16:19], s75 offen offset:0 sc1
    s_mov_b64 exec, -1
    s_mov_b32 s60, 0x3f803f80
    v_mov_b32 v4, 0
    v_mov_b32 v5, 0
    v_dot2c_f32_bf16 v4, s60, v196
    v_dot2c_f32_bf16 v5, v196, v196
    v_dot2c_f32_bf16 v4, s60, v198
    v_dot2c_f32_bf16 v5, v198, v198
    v_dot2c_f32_bf16 v4, s60, v200
    v_dot2c_f32_bf16 v5, v200, v200
    v_dot2c_f32_bf16 v4, s60, v202
    v_dot2c_f32_bf16 v5, v202, v202
    v_dot2c_f32_bf16 v4, s60, v204
    v_dot2c_f32_bf16 v5, v204, v204
    v_dot2c_f32_bf16 v4, s60, v206
    v_dot2c_f32_bf16 v5, v206, v206
    v_dot2c_f32_bf16 v4, s60, v208
    v_dot2c_f32_bf16 v5, v208, v208
    v_dot2c_f32_bf16 v4, s60, v210
    v_dot2c_f32_bf16 v5, v210, v210
    v_dot2c_f32_bf16 v4, s60, v212
    v_dot2c_f32_bf16 v5, v212, v212
    v_dot2c_f32_bf16 v4, s60, v214
    v_dot2c_f32_bf16 v5, v214, v214
    s_nop 2
    v_permlane16_swap_b32 v4, v5
    v_add_f32 v4, v4, v5
    v_mov_b32 v5, v4
    s_nop 1
    v_permlane32_swap_b32 v4, v5
    v_add_f32 v4, v4, v5
    s_mov_b32 exec_hi, 0
    buffer_store_dword v4, v16, s[16:19], s78 offen sc1
    s_mov_b32 exec_hi, -1
    s_waitcnt vmcnt(11)
    s_barrier
    s_lshr_b32 s36, s73, 4
    s_add_u32 m0, s36, 30720
    s_add_u32 s37, s73, 1376256
    buffer_load_dwordx4 v46, s[24:27], s37 offen offset:0 lds
    buffer_load_dwordx4 v47, s[24:27], s37 offen offset:1024 lds
    buffer_load_dwordx4 v48, s[24:27], s37 offen offset:2048 lds
    s_add_u32 s73, s73, 196608
    s_sub_u32 s96, s73, 589824
    s_min_u32 s73, s73, s96
    s_lshr_b32 s36, s73, 4
    s_add_u32 m0, s36, 30720
    s_add_u32 s37, s73, 1376256
    buffer_load_dwordx4 v46, s[24:27], s37 offen offset:0 lds
    v_lshlrev_b32 v176, 16, v196
    v_and_b32 v177, 0xffff0000, v196
    v_lshlrev_b32 v178, 16, v198
    v_and_b32 v179, 0xffff0000, v198
    v_lshlrev_b32 v180, 16, v200
    v_and_b32 v181, 0xffff0000, v200
    v_lshlrev_b32 v182, 16, v202
    v_and_b32 v183, 0xffff0000, v202
    v_lshlrev_b32 v184, 16, v204
    v_and_b32 v185, 0xffff0000, v204
    v_lshlrev_b32 v186, 16, v206
    v_and_b32 v187, 0xffff0000, v206
    v_lshlrev_b32 v188, 16, v208
    v_and_b32 v189, 0xffff0000, v208
    v_lshlrev_b32 v190, 16, v210
    v_and_b32 v191, 0xffff0000, v210
    v_lshlrev_b32 v192, 16, v212
    v_and_b32 v193, 0xffff0000, v212
    v_lshlrev_b32 v194, 16, v214
    v_and_b32 v195, 0xffff0000, v214
    s_lshr_b32 s59, s95, 1
    s_lshl_b32 s59, s59, 7
    s_add_u32 s59, s59, 20480
    s_mov_b32 s63, 0x7050604
    v_mov_b32 v5, 0x3010200
    v_perm_b32 v3, s63, v5, v21
    v_lshl_add_u32 v2, v19, 3, v20
    v_mul_u32_u24 v2, 192, v2
    v_lshl_add_u32 v72, v3, 3, v2
    v_add_u32 v72, 30720, v72
    v_add_u32 v73, 61440, v72
    s_mul_i32 s60, s52, 21504
    v_add_u32 v74, s60, v72
    s_mul_i32 s60, s52, 9216
    v_add_u32 v75, s60, v72
    s_waitcnt vmcnt(4)
    s_mov_b64 exec, 1
    buffer_atomic_add v15, off, s[16:19], s59 sc1
    s_mov_b64 exec, -1
    v_bfe_u32 v2, v1, 2, 3
    v_or_b32 v2, 0x0c0c0c00, v2
    s_mov_b32 s63, 0x7050604
    v_mov_b32 v5, 0x3010200
    v_perm_b32 v3, s63, v5, v2
    v_and_b32 v2, 3, v1
    v_lshl_add_u32 v2, v3, 2, v2
    v_lshlrev_b32 v2, 1, v2
    v_add_u32 v2, 155216, v2
    ds_read_u16 v9, v2 offset:0
    ds_read_u16 v10, v2 offset:64
    ds_read_u16 v11, v2 offset:128
    buffer_load_dwordx4 v47, s[24:27], s37 offen offset:1024 lds
    ds_read_b64_tr_b16 v[220:221], v74 offset:36864
    ds_read_b64_tr_b16 v[222:223], v74 offset:37632
    ds_read_b64_tr_b16 v[224:225], v74 offset:36928
    ds_read_b64_tr_b16 v[226:227], v74 offset:37696
    ds_read_b64_tr_b16 v[228:229], v74 offset:36992
    ds_read_b64_tr_b16 v[230:231], v74 offset:37760
    ds_read_b64_tr_b16 v[232:233], v74 offset:39936
    ds_read_b64_tr_b16 v[234:235], v74 offset:40704
    ds_read_b64_tr_b16 v[236:237], v74 offset:40000
    ds_read_b64_tr_b16 v[238:239], v74 offset:40768
    ds_read_b64_tr_b16 v[240:241], v74 offset:40064
    ds_read_b64_tr_b16 v[242:243], v74 offset:40832
    s_waitcnt lgkmcnt(10)
    v_mfma_f32_16x16x32_bf16 v[32:35], v[28:31], v[220:223], 0
    buffer_load_dwordx4 v48, s[24:27], s37 offen offset:2048 lds
    s_add_u32 s73, s73, 196608
    s_sub_u32 s96, s73, 589824
    s_min_u32 s73, s73, s96
    ds_read_b64_tr_b16 v[244:245], v74 offset:43008
    ds_read_b64_tr_b16 v[246:247], v74 offset:43776
    s_waitcnt lgkmcnt(10)
    v_mfma_f32_16x16x32_bf16 v[36:39], v[28:31], v[224:227], 0
    ds_read_b64_tr_b16 v[248:249], v74 offset:43072
    ds_read_b64_tr_b16 v[250:251], v74 offset:43840
    s_waitcnt lgkmcnt(10)
    v_mfma_f32_16x16x32_bf16 v[40:43], v[28:31], v[228:231], 0
    ds_read_b64_tr_b16 v[252:253], v74 offset:43136
    ds_read_b64_tr_b16 v[254:255], v74 offset:43904
    s_waitcnt lgkmcnt(10)
    v_mfma_f32_16x16x32_bf16 v[32:35], v[28:31], v[232:235], v[32:35]
    s_lshr_b32 s36, s73, 4
    s_add_u32 m0, s36, 30720
    s_add_u32 s37, s73, 1376256
    buffer_load_dwordx4 v46, s[24:27], s37 offen offset:0 lds
    ds_read_b64_tr_b16 v[220:221], v74 offset:46080
    ds_read_b64_tr_b16 v[222:223], v74 offset:46848
    s_waitcnt lgkmcnt(10)
    v_mfma_f32_16x16x32_bf16 v[36:39], v[28:31], v[236:239], v[36:39]
    ds_read_b64_tr_b16 v[224:225], v74 offset:46144
    ds_read_b64_tr_b16 v[226:227], v74 offset:46912
    s_waitcnt lgkmcnt(10)
    v_mfma_f32_16x16x32_bf16 v[40:43], v[28:31], v[240:243], v[40:43]
    ds_read_b64_tr_b16 v[228:229], v74 offset:46208
    ds_read_b64_tr_b16 v[230:231], v74 offset:46976
    s_waitcnt lgkmcnt(10)
    v_mfma_f32_16x16x32_bf16 v[32:35], v[28:31], v[244:247], v[32:35]
    buffer_load_dwordx4 v47, s[24:27], s37 offen offset:1024 lds
    ds_read_b64_tr_b16 v[232:233], v74 offset:49152
    ds_read_b64_tr_b16 v[234:235], v74 offset:49920
    s_waitcnt lgkmcnt(10)
    v_mfma_f32_16x16x32_bf16 v[36:39], v[28:31], v[248:251], v[36:39]
    ds_read_b64_tr_b16 v[236:237], v74 offset:49216
    ds_read_b64_tr_b16 v[238:239], v74 offset:49984
    s_waitcnt lgkmcnt(10)
    v_mfma_f32_16x16x32_bf16 v[40:43], v[28:31], v[252:255], v[40:43]
    ds_read_b64_tr_b16 v[240:241], v74 offset:49280
    ds_read_b64_tr_b16 v[242:243], v74 offset:50048
    s_waitcnt lgkmcnt(10)
    v_mfma_f32_16x16x32_bf16 v[32:35], v[28:31], v[220:223], v[32:35]
    buffer_load_dwordx4 v48, s[24:27], s37 offen offset:2048 lds
    ds_read_b64_tr_b16 v[244:245], v74 offset:52224
    ds_read_b64_tr_b16 v[246:247], v74 offset:52992
    s_waitcnt lgkmcnt(10)
    v_mfma_f32_16x16x32_bf16 v[36:39], v[28:31], v[224:227], v[36:39]
    ds_read_b64_tr_b16 v[248:249], v74 offset:52288
    ds_read_b64_tr_b16 v[250:251], v74 offset:53056
    s_waitcnt lgkmcnt(10)
    v_mfma_f32_16x16x32_bf16 v[40:43], v[28:31], v[228:231], v[40:43]
    ds_read_b64_tr_b16 v[252:253], v74 offset:52352
    ds_read_b64_tr_b16 v[254:255], v74 offset:53120
    s_waitcnt lgkmcnt(10)
    v_mfma_f32_16x16x32_bf16 v[32:35], v[28:31], v[232:235], v[32:35]
    buffer_load_dwordx4 a[192:195], v13, s[16:19], s5 offen offset:2048 sc1
    ds_read_b64_tr_b16 v[220:221], v74 offset:55296
    ds_read_b64_tr_b16 v[222:223], v74 offset:56064
    s_waitcnt lgkmcnt(10)
    v_mfma_f32_16x16x32_bf16 v[36:39], v[28:31], v[236:239], v[36:39]
    ds_read_b64_tr_b16 v[224:225], v74 offset:55360
    ds_read_b64_tr_b16 v[226:227], v74 offset:56128
    s_waitcnt lgkmcnt(10)
    v_mfma_f32_16x16x32_bf16 v[40:43], v[28:31], v[240:243], v[40:43]
    ds_read_b64_tr_b16 v[228:229], v74 offset:55424
    ds_read_b64_tr_b16 v[230:231], v74 offset:56192
    s_waitcnt lgkmcnt(10)
    v_mfma_f32_16x16x32_bf16 v[32:35], v[28:31], v[244:247], v[32:35]
    buffer_load_dwordx4 a[196:199], v13, s[16:19], s5 offen offset:3072 sc1
    s_waitcnt lgkmcnt(8)
    v_mfma_f32_16x16x32_bf16 v[36:39], v[28:31], v[248:251], v[36:39]
    s_waitcnt lgkmcnt(6)
    v_mfma_f32_16x16x32_bf16 v[40:43], v[28:31], v[252:255], v[40:43]
    s_waitcnt lgkmcnt(4)
    v_mfma_f32_16x16x32_bf16 v[32:35], v[28:31], v[220:223], v[32:35]
    s_waitcnt lgkmcnt(2)
    v_mfma_f32_16x16x32_bf16 v[36:39], v[28:31], v[224:227], v[36:39]
    s_waitcnt lgkmcnt(0)
    v_mfma_f32_16x16x32_bf16 v[40:43], v[28:31], v[228:231], v[40:43]
    s_lshl_b32 s60, s0, 2
    s_add_u32 s60, s60, s52
    s_lshl_b32 s61, s60, 11
    s_add_u32 s61, s61, 8388608
    s_lshl_b32 s60, s60, 7
    s_add_u32 s60, s60, 20480
    v_mov_b32 v17, 0
    s_mov_b64 exec, 1
    buffer_atomic_add v17, off, s[16:19], s60 sc0 sc1
    s_mov_b64 exec, -1
    s_add_u32 s38, s5, 4096
    buffer_load_dwordx4 a[200:203], v13, s[16:19], s38 offen offset:0 sc1
    buffer_load_dwordx4 a[204:207], v13, s[16:19], s6 offen offset:0 sc1
    buffer_load_dwordx4 a[208:211], v13, s[16:19], s6 offen offset:1024 sc1
    buffer_load_dwordx4 a[212:215], v13, s[16:19], s6 offen offset:2048 sc1
    buffer_load_dwordx4 a[216:219], v13, s[16:19], s6 offen offset:3072 sc1
    s_add_u32 s38, s6, 4096
    buffer_load_dwordx4 a[220:223], v13, s[16:19], s38 offen offset:0 sc1
    v_bfe_u32 v2, v1, 4, 1
    v_lshlrev_b32 v2, 10, v2
    v_lshl_add_u32 v2, v19, 6, v2
    v_lshl_add_u32 v2, v7, 2, v2
    s_lshl_b32 s59, s52, 11
    v_add_u32 v2, s59, v2
    s_lshl2_add_u32 s62, s0, s52
    s_mul_i32 s59, s62, 40960
    s_add_u32 s80, s59, 5242880
    s_add_u32 s81, s80, 4096
    s_add_u32 s82, s80, 8192
    s_add_u32 s83, s80, 12288
    s_add_u32 s84, s80, 16384
    s_add_u32 s85, s80, 20480
    s_add_u32 s86, s80, 24576
    s_add_u32 s87, s80, 28672
    s_add_u32 s88, s80, 32768
    s_add_u32 s89, s80, 36864
    s_mul_i32 s74, s62, 98304
    s_mul_i32 s62, s56, 3072
    s_add_u32 s74, s74, s62
    s_add_u32 s74, s74, 9437184
    v_bfe_u32 v3, v1, 4, 1
    v_mul_u32_u24 v3, 28672, v3
    v_add_u32 v23, v3, v23
    s_waitcnt vmcnt(6)
    v_readfirstlane_b32 s97, v17
    s_nop 1
    s_cmp_ge_u32 s97, 16
    s_cbranch_scc1 L_pout21
    s_mov_b32 s3, 0
L_poll20:
    v_mov_b32 v17, 0
    s_mov_b64 exec, 1
    buffer_atomic_add v17, off, s[16:19], s60 sc0 sc1
    s_mov_b64 exec, -1
    s_add_u32 s3, s3, 1
    s_waitcnt vmcnt(0)
    s_cmp_gt_u32 s3, 0x40000
    s_cbranch_scc1 L_pout21
    v_readfirstlane_b32 s97, v17
    s_nop 1
    s_cmp_lt_u32 s97, 16
    s_cbranch_scc1 L_poll20
L_pout21:
    buffer_load_dwordx4 v[76:79], v13, s[16:19], s80 offen offset:0 sc1
    buffer_load_dwordx4 v[80:83], v13, s[16:19], s80 offen offset:1024 sc1
    buffer_load_dwordx4 v[84:87], v13, s[16:19], s80 offen offset:2048 sc1
    buffer_load_dwordx4 v[88:91], v13, s[16:19], s80 offen offset:3072 sc1
    buffer_load_dwordx4 v[92:95], v13, s[16:19], s81 offen offset:0 sc1
    buffer_load_dwordx4 v[96:99], v13, s[16:19], s81 offen offset:1024 sc1
    buffer_load_dwordx4 v[100:103], v13, s[16:19], s81 offen offset:2048 sc1
    buffer_load_dwordx4 v[104:107], v13, s[16:19], s81 offen offset:3072 sc1
    buffer_load_dwordx4 v[108:111], v13, s[16:19], s82 offen offset:0 sc1
    buffer_load_dwordx4 v[112:115], v13, s[16:19], s82 offen offset:1024 sc1
    s_barrier
    ds_read_b64_tr_b16 v[220:221], v75 offset:0
    ds_read_b64_tr_b16 v[222:223], v75 offset:768
    ds_read_b64_tr_b16 v[224:225], v75 offset:64
    ds_read_b64_tr_b16 v[226:227], v75 offset:832
    ds_read_b64_tr_b16 v[228:229], v75 offset:128
    ds_read_b64_tr_b16 v[230:231], v75 offset:896
    ds_read_b64_tr_b16 v[232:233], v75 offset:3072
    ds_read_b64_tr_b16 v[234:235], v75 offset:3840
    ds_read_b64_tr_b16 v[236:237], v75 offset:3136
    ds_read_b64_tr_b16 v[238:239], v75 offset:3904
    ds_read_b64_tr_b16 v[240:241], v75 offset:3200
    ds_read_b64_tr_b16 v[242:243], v75 offset:3968
    s_waitcnt lgkmcnt(10)
    v_mfma_f32_16x16x32_bf16 v[32:35], v[28:31], v[220:223], v[32:35]
    ds_read_b64_tr_b16 v[244:245], v75 offset:6144
    ds_read_b64_tr_b16 v[246:247], v75 offset:6912
    s_waitcnt lgkmcnt(10)
    v_mfma_f32_16x16x32_bf16 v[36:39], v[28:31], v[224:227], v[36:39]
    ds_read_b64_tr_b16 v[248:249], v75 offset:6208
    ds_read_b64_tr_b16 v[250:251], v75 offset:6976
    s_waitcnt lgkmcnt(10)
    v_mfma_f32_16x16x32_bf16 v[40:43], v[28:31], v[228:231], v[40:43]
    ds_read_b64_tr_b16 v[252:253], v75 offset:6272
    ds_read_b64_tr_b16 v[254:255], v75 offset:7040
    s_waitcnt lgkmcnt(10)
    v_mfma_f32_16x16x32_bf16 v[32:35], v[28:31], v[232:235], v[32:35]
    s_waitcnt lgkmcnt(8)
    v_mfma_f32_16x16x32_bf16 v[36:39], v[28:31], v[236:239], v[36:39]
    s_waitcnt lgkmcnt(6)
    v_mfma_f32_16x16x32_bf16 v[40:43], v[28:31], v[240:243], v[40:43]
    s_waitcnt lgkmcnt(4)
    v_mfma_f32_16x16x32_bf16 v[32:35], v[28:31], v[244:247], v[32:35]
    s_waitcnt lgkmcnt(2)
    v_mfma_f32_16x16x32_bf16 v[36:39], v[28:31], v[248:251], v[36:39]
    s_waitcnt lgkmcnt(0)
    v_mfma_f32_16x16x32_bf16 v[40:43], v[28:31], v[252:255], v[40:43]
    ds_read_b64_tr_b16 v[220:221], v72 offset:36864
    ds_read_b64_tr_b16 v[222:223], v72 offset:37632
    ds_read_b64_tr_b16 v[224:225], v72 offset:36928
    ds_read_b64_tr_b16 v[226:227], v72 offset:37696
    ds_read_b64_tr_b16 v[228:229], v72 offset:36992
    ds_read_b64_tr_b16 v[230:231], v72 offset:37760
    ds_read_b64_tr_b16 v[232:233], v72 offset:39936
    ds_read_b64_tr_b16 v[234:235], v72 offset:40704
    ds_read_b64_tr_b16 v[236:237], v72 offset:40000
    ds_read_b64_tr_b16 v[238:239], v72 offset:40768
    ds_read_b64_tr_b16 v[240:241], v72 offset:40064
    ds_read_b64_tr_b16 v[242:243], v72 offset:40832
    v_mov_b32 v33, v36
    v_mov_b32 v34, v40
    ds_write_b128 v44, v[32:35]
    s_waitcnt vmcnt(9) lgkmcnt(7)
    v_mfma_f32_32x32x16_bf16 v[124:139], v[220:223], v[76:79], 0
    ds_read_b64_tr_b16 v[244:245], v72 offset:43008
    ds_read_b64_tr_b16 v[246:247], v72 offset:43776
    buffer_load_dwordx4 v[116:119], v13, s[16:19], s82 offen offset:2048 sc1
    v_mfma_f32_32x32x16_bf16 v[140:155], v[224:227], v[76:79], 0
    ds_read_b64_tr_b16 v[248:249], v72 offset:43072
    ds_read_b64_tr_b16 v[250:251], v72 offset:43840
    buffer_load_dwordx4 a[224:227], v13, s[16:19], s7 offen offset:0 sc1
    v_mfma_f32_32x32x16_bf16 v[156:171], v[228:231], v[76:79], 0
    ds_read_b64_tr_b16 v[252:253], v72 offset:43136
    ds_read_b64_tr_b16 v[254:255], v72 offset:43904
    s_waitcnt vmcnt(10) lgkmcnt(7)
    v_mfma_f32_32x32x16_bf16 v[124:139], v[232:235], v[80:83], v[124:139]
    ds_read_b64_tr_b16 v[220:221], v72 offset:46080
    ds_read_b64_tr_b16 v[222:223], v72 offset:46848
    buffer_load_dwordx4 v[120:123], v13, s[16:19], s82 offen offset:3072 sc1
    v_mfma_f32_32x32x16_bf16 v[140:155], v[236:239], v[80:83], v[140:155]
L_pad4:
    s_cbranch_execz L_padret
    ds_read_b64_tr_b16 v[224:225], v72 offset:46144
    ds_read_b64_tr_b16 v[226:227], v72 offset:46912
    v_mfma_f32_32x32x16_bf16 v[156:171], v[240:243], v[80:83], v[156:171]
    ds_read_b64_tr_b16 v[228:229], v72 offset:46208
    s_lshl_b32 m0, s52, 11
    ds_read_b64_tr_b16 v[230:231], v72 offset:46976
    buffer_load_dwordx4 v13, s[16:19], s61 offen offset:0 sc1 lds
    s_waitcnt vmcnt(11) lgkmcnt(6)
    v_mfma_f32_32x32x16_bf16 v[124:139], v[244:247], v[84:87], v[124:139]
    ds_read_b64_tr_b16 v[232:233], v72 offset:49152
    ds_read_b64_tr_b16 v[234:235], v72 offset:49920
    buffer_load_dwordx4 v[76:79], v13, s[16:19], s83 offen offset:0 sc1
    v_mfma_f32_32x32x16_bf16 v[140:155], v[248:251], v[84:87], v[140:155]
    ds_read_b64_tr_b16 v[236:237], v72 offset:49216
    ds_read_b64_tr_b16 v[238:239], v72 offset:49984
    buffer_load_dwordx4 a[228:231], v13, s[16:19], s7 offen offset:1024 sc1
    v_mfma_f32_32x32x16_bf16 v[156:171], v[252:255], v[84:87], v[156:171]
    ds_read_b64_tr_b16 v[240:241], v72 offset:49280
    s_lshl_b32 m0, s52, 11
    ds_read_b64_tr_b16 v[242:243], v72 offset:50048
    buffer_load_dwordx4 v13, s[16:19], s61 offen offset:1024 sc1 lds
    s_waitcnt vmcnt(13) lgkmcnt(6)
    v_mfma_f32_32x32x16_bf16 v[124:139], v[220:223], v[88:91], v[124:139]
    ds_read_b64_tr_b16 v[244:245], v72 offset:52224
    ds_read_b64_tr_b16 v[246:247], v72 offset:52992
    buffer_load_dwordx4 v[80:83], v13, s[16:19], s83 offen offset:1024 sc1
    v_mfma_f32_32x32x16_bf16 v[140:155], v[224:227], v[88:91], v[140:155]
    ds_read_b64_tr_b16 v[248:249], v72 offset:52288
    ds_read_b64_tr_b16 v[250:251], v72 offset:53056
    v_mfma_f32_32x32x16_bf16 v[156:171], v[228:231], v[88:91], v[156:171]
    ds_read_b64_tr_b16 v[252:253], v72 offset:52352
    ds_read_b64_tr_b16 v[254:255], v72 offset:53120
    s_barrier
    s_waitcnt vmcnt(13) lgkmcnt(6)
    v_mfma_f32_32x32x16_bf16 v[124:139], v[232:235], v[92:95], v[124:139]
    ds_read_b64_tr_b16 v[220:221], v72 offset:55296
    ds_read_b64_tr_b16 v[222:223], v72 offset:56064
    buffer_load_dwordx4 v[84:87], v13, s[16:19], s83 offen offset:2048 sc1
    v_mfma_f32_32x32x16_bf16 v[140:155], v[236:239], v[92:95], v[140:155]
    ds_read_b64_tr_b16 v[224:225], v72 offset:55360
    ds_read_b64_tr_b16 v[226:227], v72 offset:56128
    buffer_load_dwordx4 a[232:235], v13, s[16:19], s7 offen offset:2048 sc1
    v_mfma_f32_32x32x16_bf16 v[156:171], v[240:243], v[92:95], v[156:171]
    ds_read_b64_tr_b16 v[228:229], v72 offset:55424
    ds_read_b64_tr_b16 v[230:231], v72 offset:56192
    ds_read_b128 v[204:207], v45 offset:0
    ds_read_b128 v[208:211], v45 offset:1024
    s_waitcnt vmcnt(14) lgkmcnt(8)
    v_mfma_f32_32x32x16_bf16 v[124:139], v[244:247], v[96:99], v[124:139]
    ds_read_b64_tr_b16 v[232:233], v72 offset:58368
    ds_read_b64_tr_b16 v[234:235], v72 offset:59136
    buffer_load_dwordx4 v[88:91], v13, s[16:19], s83 offen offset:3072 sc1
    v_mfma_f32_32x32x16_bf16 v[140:155], v[248:251], v[96:99], v[140:155]
    ds_read_b64_tr_b16 v[236:237], v72 offset:58432
    ds_read_b64_tr_b16 v[238:239], v72 offset:59200
    v_mfma_f32_32x32x16_bf16 v[156:171], v[252:255], v[96:99], v[156:171]
    ds_read_b64_tr_b16 v[240:241], v72 offset:58496
    ds_read_b64_tr_b16 v[242:243], v72 offset:59264
    ds_read_b128 v[212:215], v45 offset:2048
    ds_read_b128 v[216:219], v45 offset:3072
    s_waitcnt vmcnt(14) lgkmcnt(10)
    v_mfma_f32_32x32x16_bf16 v[124:139], v[220:223], v[100:103], v[124:139]
    ds_read_b64_tr_b16 v[244:245], v73 offset:0
    ds_read_b64_tr_b16 v[246:247], v73 offset:768
    buffer_load_dwordx4 v[92:95], v13, s[16:19], s84 offen offset:0 sc1
    v_mfma_f32_32x32x16_bf16 v[140:155], v[224:227], v[100:103], v[140:155]
    ds_read_b64_tr_b16 v[248:249], v73 offset:64
    ds_read_b64_tr_b16 v[250:251], v73 offset:832
    buffer_load_dwordx4 a[236:239], v13, s[16:19], s7 offen offset:3072 sc1
    v_mfma_f32_32x32x16_bf16 v[156:171], v[228:231], v[100:103], v[156:171]
    ds_read_b64_tr_b16 v[252:253], v73 offset:128
    ds_read_b64_tr_b16 v[254:255], v73 offset:896
    s_waitcnt lgkmcnt(14)
    v_add_f32 v204, v204, v208
    v_add_f32 v205, v205, v209
    s_waitcnt vmcnt(15) lgkmcnt(8)
    v_mfma_f32_32x32x16_bf16 v[124:139], v[232:235], v[104:107], v[124:139]
    ds_read_b64_tr_b16 v[220:221], v73 offset:3072
    ds_read_b64_tr_b16 v[222:223], v73 offset:3840
    buffer_load_dwordx4 v[96:99], v13, s[16:19], s84 offen offset:1024 sc1
    v_mfma_f32_32x32x16_bf16 v[140:155], v[236:239], v[104:107], v[140:155]
    ds_read_b64_tr_b16 v[224:225], v73 offset:3136
    ds_read_b64_tr_b16 v[226:227], v73 offset:3904
    v_mfma_f32_32x32x16_bf16 v[156:171], v[240:243], v[104:107], v[156:171]
    ds_read_b64_tr_b16 v[228:229], v73 offset:3200
    ds_read_b64_tr_b16 v[230:231], v73 offset:3968
    v_add_f32 v206, v206, v210
    s_waitcnt lgkmcnt(12)
    v_add_f32 v212, v212, v216
    s_waitcnt vmcnt(15) lgkmcnt(6)
    v_mfma_f32_32x32x16_bf16 v[124:139], v[244:247], v[108:111], v[124:139]
    ds_read_b64_tr_b16 v[232:233], v73 offset:6144
    ds_read_b64_tr_b16 v[234:235], v73 offset:6912
    buffer_load_dwordx4 v[100:103], v13, s[16:19], s84 offen offset:2048 sc1
    v_mfma_f32_32x32x16_bf16 v[140:155], v[248:251], v[108:111], v[140:155]
    ds_read_b64_tr_b16 v[236:237], v73 offset:6208
    ds_read_b64_tr_b16 v[238:239], v73 offset:6976
    s_add_u32 s38, s7, 4096
    buffer_load_dwordx4 a[240:243], v13, s[16:19], s38 offen offset:0 sc1
    v_mfma_f32_32x32x16_bf16 v[156:171], v[252:255], v[108:111], v[156:171]
    ds_read_b64_tr_b16 v[240:241], v73 offset:6272
    ds_read_b64_tr_b16 v[242:243], v73 offset:7040
    v_add_f32 v213, v213, v217
    v_add_f32 v214, v214, v218
    s_waitcnt vmcnt(16) lgkmcnt(6)
    v_mfma_f32_32x32x16_bf16 v[124:139], v[220:223], v[112:115], v[124:139]
    ds_read_b64_tr_b16 v[244:245], v73 offset:9216
    ds_read_b64_tr_b16 v[246:247], v73 offset:9984
    buffer_load_dwordx4 v[104:107], v13, s[16:19], s84 offen offset:3072 sc1
    v_mfma_f32_32x32x16_bf16 v[140:155], v[224:227], v[112:115], v[140:155]
    ds_read_b64_tr_b16 v[248:249], v73 offset:9280
    ds_read_b64_tr_b16 v[250:251], v73 offset:10048
    v_mfma_f32_32x32x16_bf16 v[156:171], v[228:231], v[112:115], v[156:171]
    ds_read_b64_tr_b16 v[252:253], v73 offset:9344
    ds_read_b64_tr_b16 v[254:255], v73 offset:10112
    v_add_f32 v204, v204, v212
    v_add_f32 v205, v205, v213
    s_waitcnt vmcnt(16) lgkmcnt(6)
    v_mfma_f32_32x32x16_bf16 v[124:139], v[232:235], v[116:119], v[124:139]
    ds_read_b64_tr_b16 v[220:221], v73 offset:12288
    ds_read_b64_tr_b16 v[222:223], v73 offset:13056
    buffer_load_dwordx4 v[108:111], v13, s[16:19], s85 offen offset:0 sc1
    v_mfma_f32_32x32x16_bf16 v[140:155], v[236:239], v[116:119], v[140:155]
    ds_read_b64_tr_b16 v[224:225], v73 offset:12352
    ds_read_b64_tr_b16 v[226:227], v73 offset:13120
    s_add_u32 s38, s4, 4096
    buffer_load_dwordx4 a[244:247], v13, s[16:19], s38 offen offset:1024 sc1
    v_mfma_f32_32x32x16_bf16 v[156:171], v[240:243], v[116:119], v[156:171]
    ds_read_b64_tr_b16 v[228:229], v73 offset:12416
    ds_read_b64_tr_b16 v[230:231], v73 offset:13184
    v_add_f32 v206, v206, v214
    v_cvt_pk_bf16_f32 v208, v204, 0
    s_waitcnt vmcnt(16) lgkmcnt(6)
    v_mfma_f32_32x32x16_bf16 v[124:139], v[244:247], v[120:123], v[124:139]
    ds_read_b64_tr_b16 v[232:233], v73 offset:15360
    ds_read_b64_tr_b16 v[234:235], v73 offset:16128
    buffer_load_dwordx4 v[112:115], v13, s[16:19], s85 offen offset:1024 sc1
    v_mfma_f32_32x32x16_bf16 v[140:155], v[248:251], v[120:123], v[140:155]
    ds_read_b64_tr_b16 v[236:237], v73 offset:15424
    ds_read_b64_tr_b16 v[238:239], v73 offset:16192
    v_mfma_f32_32x32x16_bf16 v[156:171], v[252:255], v[120:123], v[156:171]
    ds_read_b64_tr_b16 v[240:241], v73 offset:15488
    ds_read_b64_tr_b16 v[242:243], v73 offset:16256
    v_lshlrev_b32 v209, 16, v208
    v_sub_f32 v210, v204, v209
    s_waitcnt vmcnt(15) lgkmcnt(6)
    v_mfma_f32_32x32x16_bf16 v[124:139], v[220:223], v[76:79], v[124:139]
    ds_read_b64_tr_b16 v[244:245], v73 offset:18432
    ds_read_b64_tr_b16 v[246:247], v73 offset:19200
    buffer_load_dwordx4 v[116:119], v13, s[16:19], s85 offen offset:2048 sc1
    v_mfma_f32_32x32x16_bf16 v[140:155], v[224:227], v[76:79], v[140:155]
    ds_read_b64_tr_b16 v[248:249], v73 offset:18496
    ds_read_b64_tr_b16 v[250:251], v73 offset:19264
    buffer_load_dwordx4 a[248:251], v13, s[16:19], s38 offen offset:2048 sc1
    v_mfma_f32_32x32x16_bf16 v[156:171], v[228:231], v[76:79], v[156:171]
    ds_read_b64_tr_b16 v[252:253], v73 offset:18560
    ds_read_b64_tr_b16 v[254:255], v73 offset:19328
    v_cvt_pk_bf16_f32 v58, v209, v210
    v_lshl_or_b32 v59, v9, 16, v208
    s_waitcnt vmcnt(14) lgkmcnt(6)
    v_mfma_f32_32x32x16_bf16 v[124:139], v[232:235], v[80:83], v[124:139]
    ds_read_b64_tr_b16 v[220:221], v73 offset:21504
    ds_read_b64_tr_b16 v[222:223], v73 offset:22272
    buffer_load_dwordx4 v[120:123], v13, s[16:19], s85 offen offset:3072 sc1
    v_mfma_f32_32x32x16_bf16 v[140:155], v[236:239], v[80:83], v[140:155]
    ds_read_b64_tr_b16 v[224:225], v73 offset:21568
    ds_read_b64_tr_b16 v[226:227], v73 offset:22336
    v_mfma_f32_32x32x16_bf16 v[156:171], v[240:243], v[80:83], v[156:171]
    ds_read_b64_tr_b16 v[228:229], v73 offset:21632
    ds_read_b64_tr_b16 v[230:231], v73 offset:22400
    v_mov_b32 v60, v9
    v_mov_b32 v61, 0
    s_waitcnt vmcnt(14) lgkmcnt(6)
    v_mfma_f32_32x32x16_bf16 v[124:139], v[244:247], v[84:87], v[124:139]
    ds_read_b64_tr_b16 v[232:233], v73 offset:24576
    ds_read_b64_tr_b16 v[234:235], v73 offset:25344
    buffer_load_dwordx4 v[76:79], v13, s[16:19], s86 offen offset:0 sc1
    v_mfma_f32_32x32x16_bf16 v[140:155], v[248:251], v[84:87], v[140:155]
    ds_read_b64_tr_b16 v[236:237], v73 offset:24640
    ds_read_b64_tr_b16 v[238:239], v73 offset:25408
    buffer_load_dwordx4 a[252:255], v13, s[16:19], s38 offen offset:3072 sc1
    v_mfma_f32_32x32x16_bf16 v[156:171], v[252:255], v[84:87], v[156:171]
    ds_read_b64_tr_b16 v[240:241], v73 offset:24704
    ds_read_b64_tr_b16 v[242:243], v73 offset:25472
    v_cvt_pk_bf16_f32 v208, v205, 0
    v_lshlrev_b32 v209, 16, v208
    s_waitcnt vmcnt(14) lgkmcnt(6)
    v_mfma_f32_32x32x16_bf16 v[124:139], v[220:223], v[88:91], v[124:139]
    ds_read_b64_tr_b16 v[244:245], v73 offset:27648
    ds_read_b64_tr_b16 v[246:247], v73 offset:28416
    buffer_load_dwordx4 v[80:83], v13, s[16:19], s86 offen offset:1024 sc1
    v_mfma_f32_32x32x16_bf16 v[140:155], v[224:227], v[88:91], v[140:155]
    ds_read_b64_tr_b16 v[248:249], v73 offset:27712
    ds_read_b64_tr_b16 v[250:251], v73 offset:28480
    v_mfma_f32_32x32x16_bf16 v[156:171], v[228:231], v[88:91], v[156:171]
    ds_read_b64_tr_b16 v[252:253], v73 offset:27776
    ds_read_b64_tr_b16 v[254:255], v73 offset:28544
    v_sub_f32 v210, v205, v209
    v_cvt_pk_bf16_f32 v62, v209, v210
    s_waitcnt vmcnt(14) lgkmcnt(6)
    v_mfma_f32_32x32x16_bf16 v[124:139], v[232:235], v[92:95], v[124:139]
    ds_read_b64_tr_b16 v[220:221], v73 offset:30720
    ds_read_b64_tr_b16 v[222:223], v73 offset:31488
    buffer_load_dwordx4 v[84:87], v13, s[16:19], s86 offen offset:2048 sc1
    v_mfma_f32_32x32x16_bf16 v[140:155], v[236:239], v[92:95], v[140:155]
    ds_read_b64_tr_b16 v[224:225], v73 offset:30784
    ds_read_b64_tr_b16 v[226:227], v73 offset:31552
    s_add_u32 s38, s4, 8192
    buffer_load_dwordx4 a[0:3], v13, s[16:19], s38 offen offset:0 sc1
    v_mfma_f32_32x32x16_bf16 v[156:171], v[240:243], v[92:95], v[156:171]
    ds_read_b64_tr_b16 v[228:229], v73 offset:30848
    ds_read_b64_tr_b16 v[230:231], v73 offset:31616
    v_lshl_or_b32 v63, v10, 16, v208
    v_mov_b32 v64, v10
    s_waitcnt vmcnt(14) lgkmcnt(6)
    v_mfma_f32_32x32x16_bf16 v[124:139], v[244:247], v[96:99], v[124:139]
    ds_read_b64_tr_b16 v[232:233], v73 offset:33792
    ds_read_b64_tr_b16 v[234:235], v73 offset:34560
    buffer_load_dwordx4 v[88:91], v13, s[16:19], s86 offen offset:3072 sc1
    v_mfma_f32_32x32x16_bf16 v[140:155], v[248:251], v[96:99], v[140:155]
    ds_read_b64_tr_b16 v[236:237], v73 offset:33856
    ds_read_b64_tr_b16 v[238:239], v73 offset:34624
    v_mfma_f32_32x32x16_bf16 v[156:171], v[252:255], v[96:99], v[156:171]
    ds_read_b64_tr_b16 v[240:241], v73 offset:33920
    ds_read_b64_tr_b16 v[242:243], v73 offset:34688
    v_mov_b32 v65, 0
    v_cvt_pk_bf16_f32 v208, v206, 0
    s_waitcnt vmcnt(14) lgkmcnt(6)
    v_mfma_f32_32x32x16_bf16 v[124:139], v[220:223], v[100:103], v[124:139]
    ds_read_b64_tr_b16 v[244:245], v73 offset:36864
    ds_read_b64_tr_b16 v[246:247], v73 offset:37632
    buffer_load_dwordx4 v[92:95], v13, s[16:19], s87 offen offset:0 sc1
    v_mfma_f32_32x32x16_bf16 v[140:155], v[224:227], v[100:103], v[140:155]
    ds_read_b64_tr_b16 v[248:249], v73 offset:36928
    ds_read_b64_tr_b16 v[250:251], v73 offset:37696
    buffer_load_dwordx4 a[4:7], v13, s[16:19], s38 offen offset:1024 sc1
    v_mfma_f32_32x32x16_bf16 v[156:171], v[228:231], v[100:103], v[156:171]
    ds_read_b64_tr_b16 v[252:253], v73 offset:36992
    ds_read_b64_tr_b16 v[254:255], v73 offset:37760
    v_lshlrev_b32 v209, 16, v208
    v_sub_f32 v210, v206, v209
    s_waitcnt vmcnt(14) lgkmcnt(6)
    v_mfma_f32_32x32x16_bf16 v[124:139], v[232:235], v[104:107], v[124:139]
    ds_read_b64_tr_b16 v[220:221], v73 offset:39936
    ds_read_b64_tr_b16 v[222:223], v73 offset:40704
    buffer_load_dwordx4 v[96:99], v13, s[16:19], s87 offen offset:1024 sc1
    v_mfma_f32_32x32x16_bf16 v[140:155], v[236:239], v[104:107], v[140:155]
    ds_read_b64_tr_b16 v[224:225], v73 offset:40000
    ds_read_b64_tr_b16 v[226:227], v73 offset:40768
    v_mfma_f32_32x32x16_bf16 v[156:171], v[240:243], v[104:107], v[156:171]
    ds_read_b64_tr_b16 v[228:229], v73 offset:40064
    ds_read_b64_tr_b16 v[230:231], v73 offset:40832
    v_cvt_pk_bf16_f32 v66, v209, v210
    v_lshl_or_b32 v67, v11, 16, v208
    s_waitcnt vmcnt(14) lgkmcnt(6)
    v_mfma_f32_32x32x16_bf16 v[124:139], v[244:247], v[108:111], v[124:139]
    ds_read_b64_tr_b16 v[232:233], v73 offset:43008
    ds_read_b64_tr_b16 v[234:235], v73 offset:43776
    buffer_load_dwordx4 v[100:103], v13, s[16:19], s87 offen offset:2048 sc1
    v_mfma_f32_32x32x16_bf16 v[140:155], v[248:251], v[108:111], v[140:155]
    ds_read_b64_tr_b16 v[236:237], v73 offset:43072
    ds_read_b64_tr_b16 v[238:239], v73 offset:43840
    buffer_load_dwordx4 a[8:11], v13, s[16:19], s38 offen offset:2048 sc1
    v_mfma_f32_32x32x16_bf16 v[156:171], v[252:255], v[108:111], v[156:171]
    ds_read_b64_tr_b16 v[240:241], v73 offset:43136
    ds_read_b64_tr_b16 v[242:243], v73 offset:43904
    v_mov_b32 v68, v11
    v_mov_b32 v69, 0
    s_waitcnt vmcnt(14) lgkmcnt(6)
    v_mfma_f32_32x32x16_bf16 v[124:139], v[220:223], v[112:115], v[124:139]
    ds_read_b64_tr_b16 v[244:245], v73 offset:46080
    ds_read_b64_tr_b16 v[246:247], v73 offset:46848
    buffer_load_dwordx4 v[104:107], v13, s[16:19], s87 offen offset:3072 sc1
    v_mfma_f32_32x32x16_bf16 v[140:155], v[224:227], v[112:115], v[140:155]
    ds_read_b64_tr_b16 v[248:249], v73 offset:46144
    ds_read_b64_tr_b16 v[250:251], v73 offset:46912
    v_mfma_f32_32x32x16_bf16 v[156:171], v[228:231], v[112:115], v[156:171]
    ds_read_b64_tr_b16 v[252:253], v73 offset:46208
    ds_read_b64_tr_b16 v[254:255], v73 offset:46976
    s_waitcnt vmcnt(14) lgkmcnt(6)
    v_mfma_f32_32x32x16_bf16 v[124:139], v[232:235], v[116:119], v[124:139]
    ds_read_b64_tr_b16 v[220:221], v73 offset:49152
    ds_read_b64_tr_b16 v[222:223], v73 offset:49920
    buffer_load_dwordx4 v[108:111], v13, s[16:19], s88 offen offset:0 sc1
    v_mfma_f32_32x32x16_bf16 v[140:155], v[236:239], v[116:119], v[140:155]
    ds_read_b64_tr_b16 v[224:225], v73 offset:49216
    ds_read_b64_tr_b16 v[226:227], v73 offset:49984
    buffer_load_dwordx4 a[12:15], v13, s[16:19], s38 offen offset:3072 sc1
    v_mfma_f32_32x32x16_bf16 v[156:171], v[240:243], v[116:119], v[156:171]
    ds_read_b64_tr_b16 v[228:229], v73 offset:49280
    ds_read_b64_tr_b16 v[230:231], v73 offset:50048
    s_waitcnt vmcnt(14) lgkmcnt(6)
    v_mfma_f32_32x32x16_bf16 v[124:139], v[244:247], v[120:123], v[124:139]
    ds_read_b64_tr_b16 v[232:233], v73 offset:52224
    ds_read_b64_tr_b16 v[234:235], v73 offset:52992
    buffer_load_dwordx4 v[112:115], v13, s[16:19], s88 offen offset:1024 sc1
    v_mfma_f32_32x32x16_bf16 v[140:155], v[248:251], v[120:123], v[140:155]
    ds_read_b64_tr_b16 v[236:237], v73 offset:52288
    ds_read_b64_tr_b16 v[238:239], v73 offset:53056
    v_mfma_f32_32x32x16_bf16 v[156:171], v[252:255], v[120:123], v[156:171]
    ds_read_b64_tr_b16 v[240:241], v73 offset:52352
    ds_read_b64_tr_b16 v[242:243], v73 offset:53120
    s_waitcnt vmcnt(14) lgkmcnt(6)
    v_mfma_f32_32x32x16_bf16 v[124:139], v[220:223], v[76:79], v[124:139]
    ds_read_b64_tr_b16 v[244:245], v73 offset:55296
    ds_read_b64_tr_b16 v[246:247], v73 offset:56064
    buffer_load_dwordx4 v[116:119], v13, s[16:19], s88 offen offset:2048 sc1
    v_mfma_f32_32x32x16_bf16 v[140:155], v[224:227], v[76:79], v[140:155]
    ds_read_b64_tr_b16 v[248:249], v73 offset:55360
    ds_read_b64_tr_b16 v[250:251], v73 offset:56128
    s_add_u32 s38, s4, 12288
    buffer_load_dwordx4 a[16:19], v13, s[16:19], s38 offen offset:0 sc1
    v_mfma_f32_32x32x16_bf16 v[156:171], v[228:231], v[76:79], v[156:171]
    ds_read_b64_tr_b16 v[252:253], v73 offset:55424
    ds_read_b64_tr_b16 v[254:255], v73 offset:56192
    ds_read2_b32 v[196:197], v2 offset0:0 offset1:32
    s_waitcnt vmcnt(14) lgkmcnt(7)
    v_mfma_f32_32x32x16_bf16 v[124:139], v[232:235], v[80:83], v[124:139]
    ds_read_b64_tr_b16 v[220:221], v73 offset:58368
    ds_read_b64_tr_b16 v[222:223], v73 offset:59136
    buffer_load_dwordx4 v[120:123], v13, s[16:19], s88 offen offset:3072 sc1
    v_mfma_f32_32x32x16_bf16 v[140:155], v[236:239], v[80:83], v[140:155]
    ds_read_b64_tr_b16 v[224:225], v73 offset:58432
    ds_read_b64_tr_b16 v[226:227], v73 offset:59200
    v_mfma_f32_32x32x16_bf16 v[156:171], v[240:243], v[80:83], v[156:171]
    ds_read_b64_tr_b16 v[228:229], v73 offset:58496
    ds_read_b64_tr_b16 v[230:231], v73 offset:59264
    ds_read2_b32 v[198:199], v2 offset0:64 offset1:96
    s_waitcnt vmcnt(14) lgkmcnt(8)
    v_mfma_f32_32x32x16_bf16 v[124:139], v[244:247], v[84:87], v[124:139]
    ds_read_b64_tr_b16 v[232:233], v72 offset:0
    ds_read_b64_tr_b16 v[234:235], v72 offset:768
    buffer_load_dwordx4 v[76:79], v13, s[16:19], s89 offen offset:0 sc1
    v_mfma_f32_32x32x16_bf16 v[140:155], v[248:251], v[84:87], v[140:155]
    ds_read_b64_tr_b16 v[236:237], v72 offset:64
    ds_read_b64_tr_b16 v[238:239], v72 offset:832
    buffer_load_dwordx4 a[20:23], v13, s[16:19], s38 offen offset:1024 sc1
    v_mfma_f32_32x32x16_bf16 v[156:171], v[252:255], v[84:87], v[156:171]
    ds_read_b64_tr_b16 v[240:241], v72 offset:128
    ds_read_b64_tr_b16 v[242:243], v72 offset:896
    ds_read2_b32 v[200:201], v2 offset0:128 offset1:160
    s_waitcnt vmcnt(14) lgkmcnt(8)
    v_mfma_f32_32x32x16_bf16 v[124:139], v[220:223], v[88:91], v[124:139]
    ds_read_b64_tr_b16 v[244:245], v72 offset:3072
    ds_read_b64_tr_b16 v[246:247], v72 offset:3840
    buffer_load_dwordx4 v[80:83], v13, s[16:19], s89 offen offset:1024 sc1
    v_mfma_f32_32x32x16_bf16 v[140:155], v[224:227], v[88:91], v[140:155]
    ds_read_b64_tr_b16 v[248:249], v72 offset:3136
    ds_read_b64_tr_b16 v[250:251], v72 offset:3904
    v_mfma_f32_32x32x16_bf16 v[156:171], v[228:231], v[88:91], v[156:171]
    ds_read_b64_tr_b16 v[252:253], v72 offset:3200
    ds_read_b64_tr_b16 v[254:255], v72 offset:3968
    ds_read2_b32 v[202:203], v2 offset0:192 offset1:224
    s_waitcnt vmcnt(14) lgkmcnt(8)
    v_mfma_f32_32x32x16_bf16 v[124:139], v[232:235], v[92:95], v[124:139]
    ds_read_b64_tr_b16 v[220:221], v72 offset:6144
    ds_read_b64_tr_b16 v[222:223], v72 offset:6912
    buffer_load_dwordx4 v[84:87], v13, s[16:19], s89 offen offset:2048 sc1
    v_mfma_f32_32x32x16_bf16 v[140:155], v[236:239], v[92:95], v[140:155]
    ds_read_b64_tr_b16 v[224:225], v72 offset:6208
    ds_read_b64_tr_b16 v[226:227], v72 offset:6976
    buffer_load_dwordx4 a[24:27], v13, s[16:19], s38 offen offset:2048 sc1
    v_mfma_f32_32x32x16_bf16 v[156:171], v[240:243], v[92:95], v[156:171]
    ds_read_b64_tr_b16 v[228:229], v72 offset:6272
    ds_read_b64_tr_b16 v[230:231], v72 offset:7040
    s_waitcnt vmcnt(14) lgkmcnt(7)
    v_mfma_f32_32x32x16_bf16 v[124:139], v[244:247], v[96:99], v[124:139]
    ds_read_b64_tr_b16 v[232:233], v72 offset:9216
    ds_read_b64_tr_b16 v[234:235], v72 offset:9984
    buffer_load_dwordx4 v[88:91], v13, s[16:19], s89 offen offset:3072 sc1
    v_mfma_f32_32x32x16_bf16 v[140:155], v[248:251], v[96:99], v[140:155]
    ds_read_b64_tr_b16 v[236:237], v72 offset:9280
    ds_read_b64_tr_b16 v[238:239], v72 offset:10048
    v_mfma_f32_32x32x16_bf16 v[156:171], v[252:255], v[96:99], v[156:171]
    ds_read_b64_tr_b16 v[240:241], v72 offset:9344
    ds_read_b64_tr_b16 v[242:243], v72 offset:10112
    s_waitcnt vmcnt(14) lgkmcnt(6)
    v_mfma_f32_32x32x16_bf16 v[124:139], v[220:223], v[100:103], v[124:139]
    ds_read_b64_tr_b16 v[244:245], v72 offset:12288
    ds_read_b64_tr_b16 v[246:247], v72 offset:13056
    v_add_f32 v196, v196, v200
    v_add_f32 v197, v197, v201
    v_mfma_f32_32x32x16_bf16 v[140:155], v[224:227], v[100:103], v[140:155]
    ds_read_b64_tr_b16 v[248:249], v72 offset:12352
    ds_read_b64_tr_b16 v[250:251], v72 offset:13120
    s_add_u32 s38, s5, 4096
    buffer_load_dwordx4 a[28:31], v13, s[16:19], s38 offen offset:1024 sc1
    v_mfma_f32_32x32x16_bf16 v[156:171], v[228:231], v[100:103], v[156:171]
    ds_read_b64_tr_b16 v[252:253], v72 offset:12416
    ds_read_b64_tr_b16 v[254:255], v72 offset:13184
    v_add_f32 v198, v198, v202
    v_add_f32 v199, v199, v203
    s_waitcnt vmcnt(13) lgkmcnt(6)
    v_mfma_f32_32x32x16_bf16 v[124:139], v[232:235], v[104:107], v[124:139]
    ds_read_b64_tr_b16 v[220:221], v72 offset:15360
    ds_read_b64_tr_b16 v[222:223], v72 offset:16128
    v_add_f32 v196, v196, v198
    v_add_f32 v197, v197, v199
    v_mfma_f32_32x32x16_bf16 v[140:155], v[236:239], v[104:107], v[140:155]
    ds_read_b64_tr_b16 v[224:225], v72 offset:15424
    ds_read_b64_tr_b16 v[226:227], v72 offset:16192
    buffer_load_dwordx4 a[32:35], v13, s[16:19], s38 offen offset:2048 sc1
    v_mfma_f32_32x32x16_bf16 v[156:171], v[240:243], v[104:107], v[156:171]
    ds_read_b64_tr_b16 v[228:229], v72 offset:15488
    ds_read_b64_tr_b16 v[230:231], v72 offset:16256
    v_add_f32 v196, v196, v197
    v_mov_b32 v197, v196
    s_waitcnt vmcnt(13) lgkmcnt(6)
    v_mfma_f32_32x32x16_bf16 v[124:139], v[244:247], v[108:111], v[124:139]
    ds_read_b64_tr_b16 v[232:233], v72 offset:18432
    ds_read_b64_tr_b16 v[234:235], v72 offset:19200
    v_permlane32_swap_b32 v196, v197
    v_mul_f32 v196, 0xbacccccd, v196
    v_mfma_f32_32x32x16_bf16 v[140:155], v[248:251], v[108:111], v[140:155]
    ds_read_b64_tr_b16 v[236:237], v72 offset:18496
    ds_read_b64_tr_b16 v[238:239], v72 offset:19264
    buffer_load_dwordx4 a[36:39], v13, s[16:19], s38 offen offset:3072 sc1
    v_mfma_f32_32x32x16_bf16 v[156:171], v[252:255], v[108:111], v[156:171]
    ds_read_b64_tr_b16 v[240:241], v72 offset:18560
    ds_read_b64_tr_b16 v[242:243], v72 offset:19328
    v_mul_f32 v197, 0x3acccccd, v197
    v_fma_f32 v197, -v196, v196, v197
    s_waitcnt vmcnt(12) lgkmcnt(6)
    v_mfma_f32_32x32x16_bf16 v[124:139], v[220:223], v[112:115], v[124:139]
    ds_read_b64_tr_b16 v[244:245], v72 offset:21504
    ds_read_b64_tr_b16 v[246:247], v72 offset:22272
    v_max_f32 v197, 0, v197
    v_add_f32 v198, 0x3727c5ac, v197
    v_mfma_f32_32x32x16_bf16 v[140:155], v[224:227], v[112:115], v[140:155]
    ds_read_b64_tr_b16 v[248:249], v72 offset:21568
    ds_read_b64_tr_b16 v[250:251], v72 offset:22336
    s_add_u32 s38, s5, 8192
    buffer_load_dwordx4 a[40:43], v13, s[16:19], s38 offen offset:0 sc1
    v_mfma_f32_32x32x16_bf16 v[156:171], v[228:231], v[112:115], v[156:171]
    ds_read_b64_tr_b16 v[252:253], v72 offset:21632
    ds_read_b64_tr_b16 v[254:255], v72 offset:22400
    v_fmac_f32 v197, 0x3727c5ac, v198
    v_cvt_pk_bf16_f32 v24, v196, v196
    s_waitcnt vmcnt(12) lgkmcnt(6)
    v_mfma_f32_32x32x16_bf16 v[124:139], v[232:235], v[116:119], v[124:139]
    ds_read_b64_tr_b16 v[220:221], v72 offset:24576
    ds_read_b64_tr_b16 v[222:223], v72 offset:25344
    v_sqrt_f32 v198, v197
    v_rsq_f32 v199, v197
    v_mfma_f32_32x32x16_bf16 v[140:155], v[236:239], v[116:119], v[140:155]
    ds_read_b64_tr_b16 v[224:225], v72 offset:24640
    ds_read_b64_tr_b16 v[226:227], v72 offset:25408
    buffer_load_dwordx4 a[44:47], v13, s[16:19], s38 offen offset:1024 sc1
    v_mfma_f32_32x32x16_bf16 v[156:171], v[240:243], v[116:119], v[156:171]
    ds_read_b64_tr_b16 v[228:229], v72 offset:24704
    ds_read_b64_tr_b16 v[230:231], v72 offset:25472
    v_and_b32 v200, 0xffff0000, v24
    v_sub_f32 v200, v196, v200
    s_waitcnt vmcnt(11) lgkmcnt(6)
    v_mfma_f32_32x32x16_bf16 v[124:139], v[244:247], v[120:123], v[124:139]
    ds_read_b64_tr_b16 v[232:233], v72 offset:27648
    ds_read_b64_tr_b16 v[234:235], v72 offset:28416
    v_cvt_pk_bf16_f32 v25, v200, v198
    v_and_b32 v200, 0xffff0000, v25
    v_mfma_f32_32x32x16_bf16 v[140:155], v[248:251], v[120:123], v[140:155]
    ds_read_b64_tr_b16 v[236:237], v72 offset:27712
    ds_read_b64_tr_b16 v[238:239], v72 offset:28480
    buffer_load_dwordx4 a[48:51], v13, s[16:19], s38 offen offset:2048 sc1
    v_mfma_f32_32x32x16_bf16 v[156:171], v[252:255], v[120:123], v[156:171]
    ds_read_b64_tr_b16 v[240:241], v72 offset:27776
    ds_read_b64_tr_b16 v[242:243], v72 offset:28544
    v_sub_f32 v200, v198, v200
    v_cvt_pk_bf16_f32 v26, v200, 0
    s_waitcnt vmcnt(11) lgkmcnt(6)
    v_mfma_f32_32x32x16_bf16 v[124:139], v[220:223], v[76:79], v[124:139]
    ds_read_b64_tr_b16 v[244:245], v72 offset:30720
    ds_read_b64_tr_b16 v[246:247], v72 offset:31488
    v_cndmask_b32 v24, 0, v24, s[90:91]
    v_cndmask_b32 v25, 0, v25, s[90:91]
    v_mfma_f32_32x32x16_bf16 v[140:155], v[224:227], v[76:79], v[140:155]
    ds_read_b64_tr_b16 v[248:249], v72 offset:30784
    ds_read_b64_tr_b16 v[250:251], v72 offset:31552
    buffer_load_dwordx4 a[52:55], v13, s[16:19], s38 offen offset:3072 sc1
    v_mfma_f32_32x32x16_bf16 v[156:171], v[228:231], v[76:79], v[156:171]
    ds_read_b64_tr_b16 v[252:253], v72 offset:30848
    ds_read_b64_tr_b16 v[254:255], v72 offset:31616
    v_cndmask_b32 v26, 0, v26, s[90:91]
    v_mul_f32 v200, v199, v199
    s_waitcnt vmcnt(10) lgkmcnt(6)
    v_mfma_f32_32x32x16_bf16 v[124:139], v[232:235], v[80:83], v[124:139]
    ds_read_b64_tr_b16 v[220:221], v72 offset:33792
    ds_read_b64_tr_b16 v[222:223], v72 offset:34560
    v_mul_f32 v201, 0xc0135761, v199
    v_mul_f32 v200, 0x3d372713, v200
    v_mfma_f32_32x32x16_bf16 v[140:155], v[236:239], v[80:83], v[140:155]
    ds_read_b64_tr_b16 v[224:225], v72 offset:33856
    ds_read_b64_tr_b16 v[226:227], v72 offset:34624
    s_add_u32 s38, s5, 12288
    buffer_load_dwordx4 a[56:59], v13, s[16:19], s38 offen offset:0 sc1
    v_mfma_f32_32x32x16_bf16 v[156:171], v[240:243], v[80:83], v[156:171]
    ds_read_b64_tr_b16 v[228:229], v72 offset:33920
    ds_read_b64_tr_b16 v[230:231], v72 offset:34688
    v_mul_f32 v200, v201, v200
    s_waitcnt vmcnt(10) lgkmcnt(6)
    v_mfma_f32_32x32x16_bf16 v[124:139], v[244:247], v[84:87], v[124:139]
    v_mfma_f32_32x32x16_bf16 v[140:155], v[248:251], v[84:87], v[140:155]
    buffer_load_dwordx4 a[60:63], v13, s[16:19], s38 offen offset:1024 sc1
    v_mfma_f32_32x32x16_bf16 v[156:171], v[252:255], v[84:87], v[156:171]
    s_waitcnt vmcnt(9) lgkmcnt(0)
    v_mfma_f32_32x32x16_bf16 v[124:139], v[220:223], v[88:91], v[124:139]
    v_mfma_f32_32x32x16_bf16 v[140:155], v[224:227], v[88:91], v[140:155]
    buffer_load_dwordx4 a[64:67], v13, s[16:19], s38 offen offset:2048 sc1
    v_mfma_f32_32x32x16_bf16 v[156:171], v[228:231], v[88:91], v[156:171]
    s_add_u32 s38, s6, 4096
    buffer_load_dwordx4 a[68:71], v13, s[16:19], s38 offen offset:1024 sc1
    v_mfma_f32_32x32x16_bf16 v[124:139], v[58:61], v[24:27], v[124:139]
    v_mfma_f32_32x32x16_bf16 v[140:155], v[62:65], v[24:27], v[140:155]
    v_mfma_f32_32x32x16_bf16 v[156:171], v[66:69], v[24:27], v[156:171]
    s_lshl_b32 s59, s0, 1
    s_add_u32 s59, s59, s99
    s_lshl_b32 s59, s59, 2
    s_lshr_b32 s60, s56, 2
    s_add_u32 s59, s59, s60
    s_lshl_b32 s59, s59, 7
    s_add_u32 s59, s59, 32768
    s_lshl_b32 s60, s95, 7
    s_add_u32 s60, s60, 32768
    s_nop 0
    v_pk_mul_f32 v[28:29], v[124:125], v[124:125]
    v_pk_mul_f32 v[30:31], v[126:127], v[126:127]
    v_pk_mul_f32 v[32:33], v[128:129], v[128:129]
    v_pk_mul_f32 v[34:35], v[130:131], v[130:131]
    v_pk_fma_f32 v[28:29], v[28:29], v[200:201], v[200:201] op_sel:[0,0,1] op_sel_hi:[1,0,1]
    v_pk_fma_f32 v[30:31], v[30:31], v[200:201], v[200:201] op_sel:[0,0,1] op_sel_hi:[1,0,1]
    v_pk_fma_f32 v[32:33], v[32:33], v[200:201], v[200:201] op_sel:[0,0,1] op_sel_hi:[1,0,1]
    v_pk_fma_f32 v[34:35], v[34:35], v[200:201], v[200:201] op_sel:[0,0,1] op_sel_hi:[1,0,1]
    v_pk_mul_f32 v[28:29], v[28:29], v[124:125]
    v_pk_mul_f32 v[30:31], v[30:31], v[126:127]
    v_pk_mul_f32 v[32:33], v[32:33], v[128:129]
    buffer_load_dwordx4 a[72:75], v13, s[16:19], s38 offen offset:2048 sc1
    v_pk_mul_f32 v[34:35], v[34:35], v[130:131]
    v_exp_f32 v28, v28
    v_exp_f32 v29, v29
    v_exp_f32 v30, v30
    v_exp_f32 v31, v31
    v_exp_f32 v32, v32
    v_exp_f32 v33, v33
    v_exp_f32 v34, v34
    v_exp_f32 v35, v35
    v_pk_fma_f32 v[28:29], v[28:29], v[198:199], v[198:199] op_sel_hi:[1,0,0]
    v_pk_fma_f32 v[30:31], v[30:31], v[198:199], v[198:199] op_sel_hi:[1,0,0]
    v_pk_fma_f32 v[32:33], v[32:33], v[198:199], v[198:199] op_sel_hi:[1,0,0]
    v_pk_fma_f32 v[34:35], v[34:35], v[198:199], v[198:199] op_sel_hi:[1,0,0]
    v_rcp_f32 v28, v28
    v_rcp_f32 v29, v29
    v_rcp_f32 v30, v30
    v_rcp_f32 v31, v31
    v_rcp_f32 v32, v32
    v_rcp_f32 v33, v33
    v_rcp_f32 v34, v34
    v_rcp_f32 v35, v35
    v_pk_mul_f32 v[28:29], v[28:29], v[124:125]
    v_pk_mul_f32 v[30:31], v[30:31], v[126:127]
    v_pk_mul_f32 v[32:33], v[32:33], v[128:129]
    v_pk_mul_f32 v[34:35], v[34:35], v[130:131]
    v_cvt_pk_bf16_f32 v72, v28, v29
    v_cvt_pk_bf16_f32 v73, v30, v31
    v_cvt_pk_bf16_f32 v74, v32, v33
    v_cvt_pk_bf16_f32 v75, v34, v35
L_pad5:
    s_cbranch_execz L_padret
    buffer_store_dwordx4 v[72:75], v23, s[16:19], s74 offen offset:0 sc1
    v_pk_mul_f32 v[28:29], v[132:133], v[132:133]
    v_pk_mul_f32 v[30:31], v[134:135], v[134:135]
    v_pk_mul_f32 v[32:33], v[136:137], v[136:137]
    v_pk_mul_f32 v[34:35], v[138:139], v[138:139]
    v_pk_fma_f32 v[28:29], v[28:29], v[200:201], v[200:201] op_sel:[0,0,1] op_sel_hi:[1,0,1]
    v_pk_fma_f32 v[30:31], v[30:31], v[200:201], v[200:201] op_sel:[0,0,1] op_sel_hi:[1,0,1]
    v_pk_fma_f32 v[32:33], v[32:33], v[200:201], v[200:201] op_sel:[0,0,1] op_sel_hi:[1,0,1]
    v_pk_fma_f32 v[34:35], v[34:35], v[200:201], v[200:201] op_sel:[0,0,1] op_sel_hi:[1,0,1]
    v_pk_mul_f32 v[28:29], v[28:29], v[132:133]
    v_pk_mul_f32 v[30:31], v[30:31], v[134:135]
    v_pk_mul_f32 v[32:33], v[32:33], v[136:137]
    v_pk_mul_f32 v[34:35], v[34:35], v[138:139]
    v_exp_f32 v28, v28
    v_exp_f32 v29, v29
    v_exp_f32 v30, v30
    v_exp_f32 v31, v31
    v_exp_f32 v32, v32
    v_exp_f32 v33, v33
    v_exp_f32 v34, v34
    v_exp_f32 v35, v35
    v_pk_fma_f32 v[28:29], v[28:29], v[198:199], v[198:199] op_sel_hi:[1,0,0]
    v_pk_fma_f32 v[30:31], v[30:31], v[198:199], v[198:199] op_sel_hi:[1,0,0]
    v_pk_fma_f32 v[32:33], v[32:33], v[198:199], v[198:199] op_sel_hi:[1,0,0]
    v_pk_fma_f32 v[34:35], v[34:35], v[198:199], v[198:199] op_sel_hi:[1,0,0]
    v_rcp_f32 v28, v28
    v_rcp_f32 v29, v29
    v_rcp_f32 v30, v30
    v_rcp_f32 v31, v31
    v_rcp_f32 v32, v32
    v_rcp_f32 v33, v33
    v_rcp_f32 v34, v34
    v_rcp_f32 v35, v35
    v_pk_mul_f32 v[28:29], v[28:29], v[132:133]
    v_pk_mul_f32 v[30:31], v[30:31], v[134:135]
    v_pk_mul_f32 v[32:33], v[32:33], v[136:137]
    v_pk_mul_f32 v[34:35], v[34:35], v[138:139]
    v_cvt_pk_bf16_f32 v76, v28, v29
    v_cvt_pk_bf16_f32 v77, v30, v31
    v_cvt_pk_bf16_f32 v78, v32, v33
    v_cvt_pk_bf16_f32 v79, v34, v35
    buffer_store_dwordx4 v[76:79], v23, s[16:19], s74 offen offset:512 sc1
    v_pk_mul_f32 v[28:29], v[140:141], v[140:141]
    v_pk_mul_f32 v[30:31], v[142:143], v[142:143]
    v_pk_mul_f32 v[32:33], v[144:145], v[144:145]
    v_pk_mul_f32 v[34:35], v[146:147], v[146:147]
    v_pk_fma_f32 v[28:29], v[28:29], v[200:201], v[200:201] op_sel:[0,0,1] op_sel_hi:[1,0,1]
    v_pk_fma_f32 v[30:31], v[30:31], v[200:201], v[200:201] op_sel:[0,0,1] op_sel_hi:[1,0,1]
    v_pk_fma_f32 v[32:33], v[32:33], v[200:201], v[200:201] op_sel:[0,0,1] op_sel_hi:[1,0,1]
    v_pk_fma_f32 v[34:35], v[34:35], v[200:201], v[200:201] op_sel:[0,0,1] op_sel_hi:[1,0,1]
    v_pk_mul_f32 v[28:29], v[28:29], v[140:141]
    v_pk_mul_f32 v[30:31], v[30:31], v[142:143]
    v_pk_mul_f32 v[32:33], v[32:33], v[144:145]
    v_pk_mul_f32 v[34:35], v[34:35], v[146:147]
    v_exp_f32 v28, v28
    v_exp_f32 v29, v29
    v_exp_f32 v30, v30
    v_exp_f32 v31, v31
    v_exp_f32 v32, v32
    v_exp_f32 v33, v33
    v_exp_f32 v34, v34
    v_exp_f32 v35, v35
    v_pk_fma_f32 v[28:29], v[28:29], v[198:199], v[198:199] op_sel_hi:[1,0,0]
    v_pk_fma_f32 v[30:31], v[30:31], v[198:199], v[198:199] op_sel_hi:[1,0,0]
    v_pk_fma_f32 v[32:33], v[32:33], v[198:199], v[198:199] op_sel_hi:[1,0,0]
    v_pk_fma_f32 v[34:35], v[34:35], v[198:199], v[198:199] op_sel_hi:[1,0,0]
    v_rcp_f32 v28, v28
    v_rcp_f32 v29, v29
    v_rcp_f32 v30, v30
    v_rcp_f32 v31, v31
    v_rcp_f32 v32, v32
    v_rcp_f32 v33, v33
    v_rcp_f32 v34, v34
    v_rcp_f32 v35, v35
    v_pk_mul_f32 v[28:29], v[28:29], v[140:141]
    v_pk_mul_f32 v[30:31], v[30:31], v[142:143]
    v_pk_mul_f32 v[32:33], v[32:33], v[144:145]
    v_pk_mul_f32 v[34:35], v[34:35], v[146:147]
    v_cvt_pk_bf16_f32 v80, v28, v29
    v_cvt_pk_bf16_f32 v81, v30, v31
    v_cvt_pk_bf16_f32 v82, v32, v33
    v_cvt_pk_bf16_f32 v83, v34, v35
    buffer_store_dwordx4 v[80:83], v23, s[16:19], s74 offen offset:1024 sc1
    v_pk_mul_f32 v[28:29], v[148:149], v[148:149]
    v_pk_mul_f32 v[30:31], v[150:151], v[150:151]
    v_pk_mul_f32 v[32:33], v[152:153], v[152:153]
    v_pk_mul_f32 v[34:35], v[154:155], v[154:155]
    v_pk_fma_f32 v[28:29], v[28:29], v[200:201], v[200:201] op_sel:[0,0,1] op_sel_hi:[1,0,1]
    v_pk_fma_f32 v[30:31], v[30:31], v[200:201], v[200:201] op_sel:[0,0,1] op_sel_hi:[1,0,1]
    v_pk_fma_f32 v[32:33], v[32:33], v[200:201], v[200:201] op_sel:[0,0,1] op_sel_hi:[1,0,1]
    v_pk_fma_f32 v[34:35], v[34:35], v[200:201], v[200:201] op_sel:[0,0,1] op_sel_hi:[1,0,1]
    v_pk_mul_f32 v[28:29], v[28:29], v[148:149]
    v_pk_mul_f32 v[30:31], v[30:31], v[150:151]
    v_pk_mul_f32 v[32:33], v[32:33], v[152:153]
    v_pk_mul_f32 v[34:35], v[34:35], v[154:155]
    v_exp_f32 v28, v28
    v_exp_f32 v29, v29
    v_exp_f32 v30, v30
    v_exp_f32 v31, v31
    v_exp_f32 v32, v32
    v_exp_f32 v33, v33
    v_exp_f32 v34, v34
    v_exp_f32 v35, v35
    v_pk_fma_f32 v[28:29], v[28:29], v[198:199], v[198:199] op_sel_hi:[1,0,0]
    v_pk_fma_f32 v[30:31], v[30:31], v[198:199], v[198:199] op_sel_hi:[1,0,0]
    v_pk_fma_f32 v[32:33], v[32:33], v[198:199], v[198:199] op_sel_hi:[1,0,0]
    v_pk_fma_f32 v[34:35], v[34:35], v[198:199], v[198:199] op_sel_hi:[1,0,0]
    v_rcp_f32 v28, v28
    v_rcp_f32 v29, v29
    v_rcp_f32 v30, v30
    v_rcp_f32 v31, v31
    v_rcp_f32 v32, v32
    v_rcp_f32 v33, v33
    v_rcp_f32 v34, v34
    v_rcp_f32 v35, v35
    v_pk_mul_f32 v[28:29], v[28:29], v[148:149]
    v_pk_mul_f32 v[30:31], v[30:31], v[150:151]
    v_pk_mul_f32 v[32:33], v[32:33], v[152:153]
    v_pk_mul_f32 v[34:35], v[34:35], v[154:155]
    v_cvt_pk_bf16_f32 v84, v28, v29
    v_cvt_pk_bf16_f32 v85, v30, v31
    v_cvt_pk_bf16_f32 v86, v32, v33
    v_cvt_pk_bf16_f32 v87, v34, v35
    buffer_store_dwordx4 v[84:87], v23, s[16:19], s74 offen offset:1536 sc1
    v_pk_mul_f32 v[28:29], v[156:157], v[156:157]
    v_pk_mul_f32 v[30:31], v[158:159], v[158:159]
    v_pk_mul_f32 v[32:33], v[160:161], v[160:161]
    v_pk_mul_f32 v[34:35], v[162:163], v[162:163]
    v_pk_fma_f32 v[28:29], v[28:29], v[200:201], v[200:201] op_sel:[0,0,1] op_sel_hi:[1,0,1]
    v_pk_fma_f32 v[30:31], v[30:31], v[200:201], v[200:201] op_sel:[0,0,1] op_sel_hi:[1,0,1]
    v_pk_fma_f32 v[32:33], v[32:33], v[200:201], v[200:201] op_sel:[0,0,1] op_sel_hi:[1,0,1]
    v_pk_fma_f32 v[34:35], v[34:35], v[200:201], v[200:201] op_sel:[0,0,1] op_sel_hi:[1,0,1]
    v_pk_mul_f32 v[28:29], v[28:29], v[156:157]
    v_pk_mul_f32 v[30:31], v[30:31], v[158:159]
    v_pk_mul_f32 v[32:33], v[32:33], v[160:161]
    v_pk_mul_f32 v[34:35], v[34:35], v[162:163]
    v_exp_f32 v28, v28
    v_exp_f32 v29, v29
    v_exp_f32 v30, v30
    v_exp_f32 v31, v31
    v_exp_f32 v32, v32
    v_exp_f32 v33, v33
    v_exp_f32 v34, v34
    v_exp_f32 v35, v35
    v_pk_fma_f32 v[28:29], v[28:29], v[198:199], v[198:199] op_sel_hi:[1,0,0]
    v_pk_fma_f32 v[30:31], v[30:31], v[198:199], v[198:199] op_sel_hi:[1,0,0]
    v_pk_fma_f32 v[32:33], v[32:33], v[198:199], v[198:199] op_sel_hi:[1,0,0]
    v_pk_fma_f32 v[34:35], v[34:35], v[198:199], v[198:199] op_sel_hi:[1,0,0]
    v_rcp_f32 v28, v28
    v_rcp_f32 v29, v29
    v_rcp_f32 v30, v30
    v_rcp_f32 v31, v31
    v_rcp_f32 v32, v32
    v_rcp_f32 v33, v33
    v_rcp_f32 v34, v34
    v_rcp_f32 v35, v35
    v_pk_mul_f32 v[28:29], v[28:29], v[156:157]
    v_pk_mul_f32 v[30:31], v[30:31], v[158:159]
    v_pk_mul_f32 v[32:33], v[32:33], v[160:161]
    v_pk_mul_f32 v[34:35], v[34:35], v[162:163]
    v_cvt_pk_bf16_f32 v88, v28, v29
    v_cvt_pk_bf16_f32 v89, v30, v31
    v_cvt_pk_bf16_f32 v90, v32, v33
    v_cvt_pk_bf16_f32 v91, v34, v35
    s_waitcnt vmcnt(2)
    s_mov_b64 exec, 1
    buffer_atomic_add v15, off, s[16:19], s59 sc1
    s_mov_b64 exec, -1
    buffer_store_dwordx4 v[88:91], v23, s[16:19], s74 offen offset:2048 sc1
    v_pk_mul_f32 v[28:29], v[164:165], v[164:165]
    v_pk_mul_f32 v[30:31], v[166:167], v[166:167]
    v_pk_mul_f32 v[32:33], v[168:169], v[168:169]
    v_pk_mul_f32 v[34:35], v[170:171], v[170:171]
    v_pk_fma_f32 v[28:29], v[28:29], v[200:201], v[200:201] op_sel:[0,0,1] op_sel_hi:[1,0,1]
    v_pk_fma_f32 v[30:31], v[30:31], v[200:201], v[200:201] op_sel:[0,0,1] op_sel_hi:[1,0,1]
    v_pk_fma_f32 v[32:33], v[32:33], v[200:201], v[200:201] op_sel:[0,0,1] op_sel_hi:[1,0,1]
    v_pk_fma_f32 v[34:35], v[34:35], v[200:201], v[200:201] op_sel:[0,0,1] op_sel_hi:[1,0,1]
    v_pk_mul_f32 v[28:29], v[28:29], v[164:165]
    v_pk_mul_f32 v[30:31], v[30:31], v[166:167]
    v_pk_mul_f32 v[32:33], v[32:33], v[168:169]
    v_pk_mul_f32 v[34:35], v[34:35], v[170:171]
    v_exp_f32 v28, v28
    v_exp_f32 v29, v29
    v_exp_f32 v30, v30
    v_exp_f32 v31, v31
    v_exp_f32 v32, v32
    v_exp_f32 v33, v33
    v_exp_f32 v34, v34
    v_exp_f32 v35, v35
    v_pk_fma_f32 v[28:29], v[28:29], v[198:199], v[198:199] op_sel_hi:[1,0,0]
    v_pk_fma_f32 v[30:31], v[30:31], v[198:199], v[198:199] op_sel_hi:[1,0,0]
    v_pk_fma_f32 v[32:33], v[32:33], v[198:199], v[198:199] op_sel_hi:[1,0,0]
    v_pk_fma_f32 v[34:35], v[34:35], v[198:199], v[198:199] op_sel_hi:[1,0,0]
    v_rcp_f32 v28, v28
    v_rcp_f32 v29, v29
    v_rcp_f32 v30, v30
    v_rcp_f32 v31, v31
    v_rcp_f32 v32, v32
    v_rcp_f32 v33, v33
    v_rcp_f32 v34, v34
    v_rcp_f32 v35, v35
    v_pk_mul_f32 v[28:29], v[28:29], v[164:165]
    v_pk_mul_f32 v[30:31], v[30:31], v[166:167]
    v_pk_mul_f32 v[32:33], v[32:33], v[168:169]
    v_pk_mul_f32 v[34:35], v[34:35], v[170:171]
    v_cvt_pk_bf16_f32 v92, v28, v29
    v_cvt_pk_bf16_f32 v93, v30, v31
    v_cvt_pk_bf16_f32 v94, v32, v33
    v_cvt_pk_bf16_f32 v95, v34, v35
    v_mov_b32 v17, 0
    s_mov_b64 exec, 1
    buffer_atomic_add v17, off, s[16:19], s60 sc0 sc1
    s_mov_b64 exec, -1
    buffer_store_dwordx4 v[92:95], v23, s[16:19], s74 offen offset:2560 sc1
    v_lshlrev_b32 v3, 3, v6
    v_add_u32 v3, 155408, v3
    ds_read_b64 v[24:25], v3 offset:0
    ds_read_b64 v[26:27], v3 offset:32
    ds_read_b64 v[28:29], v3 offset:64
    ds_read_b64 v[30:31], v3 offset:96
    ds_read_b64 v[32:33], v3 offset:128
    buffer_load_dwordx4 a[76:79], v13, s[16:19], s38 offen offset:3072 sc1
    s_add_u32 s38, s6, 8192
    buffer_load_dwordx4 a[80:83], v13, s[16:19], s38 offen offset:0 sc1
    buffer_load_dwordx4 a[84:87], v13, s[16:19], s38 offen offset:1024 sc1
    s_add_u32 s75, s59, 16384
    s_add_u32 s76, s60, 16384
    s_and_b32 s59, s95, -4
    s_lshl2_add_u32 s59, s59, s52
    s_mul_i32 s59, s59, 12288
    s_add_u32 s59, s59, 9437184
    s_and_b32 s62, s2, 7
    s_lshl_b32 s62, s62, 2
    s_lshr_b32 s62, 0x32103210, s62
    s_and_b32 s62, s62, 7
    s_mul_i32 s62, s62, 3072
    s_add_u32 s80, s59, s62
    s_add_u32 s62, s62, 3072
    s_sub_u32 s63, s62, 12288
    s_min_u32 s62, s62, s63
    s_add_u32 s81, s59, s62
    s_add_u32 s62, s62, 3072
    s_sub_u32 s63, s62, 12288
    s_min_u32 s62, s62, s63
    s_add_u32 s82, s59, s62
    s_add_u32 s62, s62, 3072
    s_sub_u32 s63, s62, 12288
    s_min_u32 s62, s62, s63
    s_add_u32 s83, s59, s62
    s_xor_b32 s61, s52, 0
    s_mul_i32 s61, s61, 49152
    v_add_u32 v50, s61, v13
    s_xor_b32 s61, s52, 1
    s_mul_i32 s61, s61, 49152
    v_add_u32 v51, s61, v13
    s_xor_b32 s61, s52, 2
    s_mul_i32 s61, s61, 49152
    v_add_u32 v52, s61, v13
    s_xor_b32 s61, s52, 3
    s_mul_i32 s61, s61, 49152
    v_add_u32 v53, s61, v13
    v_mul_u32_u24 v2, 1280, v7
    v_lshl_add_u32 v2, v8, 4, v2
    s_mul_i32 s74, s95, 20480
    s_mul_i32 s61, s57, 160
    s_add_u32 s74, s74, s61
    s_mul_i32 s61, s52, 4096
    s_add_u32 s61, s61, 65536
    v_mul_u32_u24 v34, 176, v7
    v_lshl_add_u32 v34, v6, 3, v34
    v_add_u32 v34, s61, v34
    s_movk_i32 s62, 1120
    v_add_u32 v4, 0, v1
    v_mul_u32_u24 v5, 6554, v4
    v_lshrrev_b32 v5, 16, v5
    v_lshlrev_b32 v4, 4, v4
    v_mad_u32_u24 v38, v5, s62, v4
    v_lshl_add_u32 v4, v5, 4, v4
    v_add_u32 v35, s61, v4
    v_add_u32 v4, 64, v1
    v_mul_u32_u24 v5, 6554, v4
    v_lshrrev_b32 v5, 16, v5
    v_lshlrev_b32 v4, 4, v4
    v_mad_u32_u24 v39, v5, s62, v4
    v_lshl_add_u32 v4, v5, 4, v4
    v_add_u32 v36, s61, v4
    v_add_u32 v4, 128, v1
    v_mul_u32_u24 v5, 6554, v4
    v_lshrrev_b32 v5, 16, v5
    v_lshlrev_b32 v4, 4, v4
    v_mad_u32_u24 v40, v5, s62, v4
    v_lshl_add_u32 v4, v5, 4, v4
    v_add_u32 v37, s61, v4
    s_waitcnt vmcnt(4)
    v_readfirstlane_b32 s97, v17
    s_nop 1
    s_cmp_ge_u32 s97, 8
    s_cbranch_scc1 L_pout23
    s_mov_b32 s3, 0
L_poll22:
    v_mov_b32 v17, 0
    s_mov_b64 exec, 1
    buffer_atomic_add v17, off, s[16:19], s60 sc0 sc1
    s_mov_b64 exec, -1
    s_add_u32 s3, s3, 1
    s_waitcnt vmcnt(0)
    s_cmp_gt_u32 s3, 0x40000
    s_cbranch_scc1 L_pout23
    v_readfirstlane_b32 s97, v17
    s_nop 1
    s_cmp_lt_u32 s97, 8
    s_cbranch_scc1 L_poll22
L_pout23:
    buffer_load_dwordx4 v[60:63], v51, s[16:19], s80 offen offset:0 sc1
    buffer_load_dwordx4 v[64:67], v51, s[16:19], s81 offen offset:0 sc1
    buffer_load_dwordx4 v[68:71], v51, s[16:19], s82 offen offset:0 sc1
    buffer_load_dwordx4 v[72:75], v51, s[16:19], s83 offen offset:0 sc1
    buffer_load_dwordx4 v[76:79], v52, s[16:19], s80 offen offset:0 sc1
    buffer_load_dwordx4 v[80:83], v52, s[16:19], s81 offen offset:0 sc1
    buffer_load_dwordx4 v[84:87], v52, s[16:19], s82 offen offset:0 sc1
    buffer_load_dwordx4 v[88:91], v52, s[16:19], s83 offen offset:0 sc1
    s_waitcnt vmcnt(11)
    s_mov_b64 exec, 1
    buffer_atomic_add v15, off, s[16:19], s75 sc1
    s_mov_b64 exec, -1
    s_waitcnt lgkmcnt(4)
    v_lshlrev_b32 v4, 16, v24
    v_and_b32 v5, 0xffff0000, v24
    v_add_f32 v176, v176, v4
    v_add_f32 v177, v177, v5
    v_lshlrev_b32 v4, 16, v25
    v_and_b32 v5, 0xffff0000, v25
    v_add_f32 v178, v178, v4
    v_add_f32 v179, v179, v5
    s_waitcnt lgkmcnt(3)
    v_lshlrev_b32 v4, 16, v26
    v_and_b32 v5, 0xffff0000, v26
    v_add_f32 v180, v180, v4
    v_add_f32 v181, v181, v5
    v_lshlrev_b32 v4, 16, v27
    v_and_b32 v5, 0xffff0000, v27
    v_add_f32 v182, v182, v4
    v_add_f32 v183, v183, v5
    s_waitcnt lgkmcnt(2)
    v_lshlrev_b32 v4, 16, v28
    v_and_b32 v5, 0xffff0000, v28
    v_add_f32 v184, v184, v4
    v_add_f32 v185, v185, v5
    v_lshlrev_b32 v4, 16, v29
    v_and_b32 v5, 0xffff0000, v29
    v_add_f32 v186, v186, v4
    v_add_f32 v187, v187, v5
    s_waitcnt lgkmcnt(1)
    v_lshlrev_b32 v4, 16, v30
    v_and_b32 v5, 0xffff0000, v30
    v_add_f32 v188, v188, v4
    v_add_f32 v189, v189, v5
    v_lshlrev_b32 v4, 16, v31
    v_and_b32 v5, 0xffff0000, v31
    v_add_f32 v190, v190, v4
    v_add_f32 v191, v191, v5
    s_waitcnt lgkmcnt(0)
    v_lshlrev_b32 v4, 16, v32
    v_and_b32 v5, 0xffff0000, v32
    v_add_f32 v192, v192, v4
    v_add_f32 v193, v193, v5
    v_lshlrev_b32 v4, 16, v33
    v_and_b32 v5, 0xffff0000, v33
    v_add_f32 v194, v194, v4
    v_add_f32 v195, v195, v5
    s_waitcnt vmcnt(8)
    v_mfma_f32_16x16x32_bf16 v[196:199], a[164:167], v[60:63], 0
    buffer_load_dwordx4 v[92:95], v53, s[16:19], s80 offen offset:0 sc1
    v_mfma_f32_16x16x32_bf16 v[200:203], a[168:171], v[60:63], 0
    v_mfma_f32_16x16x32_bf16 v[204:207], a[172:175], v[60:63], 0
    buffer_load_dwordx4 a[88:91], v13, s[16:19], s38 offen offset:2048 sc1
    v_mfma_f32_16x16x32_bf16 v[208:211], a[176:179], v[60:63], 0
    v_mfma_f32_16x16x32_bf16 v[212:215], a[180:183], v[60:63], 0
    v_mov_b32 v17, 0
    s_mov_b64 exec, 1
    buffer_atomic_add v17, off, s[16:19], s76 sc0 sc1
    s_mov_b64 exec, -1
    s_waitcnt vmcnt(10)
    v_mfma_f32_16x16x32_bf16 v[196:199], a[184:187], v[64:67], v[196:199]
    buffer_load_dwordx4 v[96:99], v53, s[16:19], s81 offen offset:0 sc1
    v_mfma_f32_16x16x32_bf16 v[200:203], a[188:191], v[64:67], v[200:203]
    v_mfma_f32_16x16x32_bf16 v[204:207], a[192:195], v[64:67], v[204:207]
    buffer_load_dwordx4 a[92:95], v13, s[16:19], s38 offen offset:3072 sc1
    v_mfma_f32_16x16x32_bf16 v[208:211], a[196:199], v[64:67], v[208:211]
    v_mfma_f32_16x16x32_bf16 v[212:215], a[200:203], v[64:67], v[212:215]
    s_waitcnt vmcnt(11)
    v_mfma_f32_16x16x32_bf16 v[196:199], a[204:207], v[68:71], v[196:199]
    buffer_load_dwordx4 v[100:103], v53, s[16:19], s82 offen offset:0 sc1
    v_mfma_f32_16x16x32_bf16 v[200:203], a[208:211], v[68:71], v[200:203]
    v_mfma_f32_16x16x32_bf16 v[204:207], a[212:215], v[68:71], v[204:207]
    s_add_u32 s38, s6, 12288
    buffer_load_dwordx4 a[96:99], v13, s[16:19], s38 offen offset:0 sc1
    v_mfma_f32_16x16x32_bf16 v[208:211], a[216:219], v[68:71], v[208:211]
    v_mfma_f32_16x16x32_bf16 v[212:215], a[220:223], v[68:71], v[212:215]
    s_waitcnt vmcnt(12)
    v_mfma_f32_16x16x32_bf16 v[196:199], a[224:227], v[72:75], v[196:199]
    buffer_load_dwordx4 v[104:107], v53, s[16:19], s83 offen offset:0 sc1
    v_mfma_f32_16x16x32_bf16 v[200:203], a[228:231], v[72:75], v[200:203]
    v_mfma_f32_16x16x32_bf16 v[204:207], a[232:235], v[72:75], v[204:207]
    buffer_load_dwordx4 a[100:103], v13, s[16:19], s38 offen offset:1024 sc1
    v_mfma_f32_16x16x32_bf16 v[208:211], a[236:239], v[72:75], v[208:211]
    v_mfma_f32_16x16x32_bf16 v[212:215], a[240:243], v[72:75], v[212:215]
    s_waitcnt vmcnt(13)
    v_mfma_f32_16x16x32_bf16 v[216:219], a[164:167], v[76:79], 0
    buffer_load_dwordx4 v[108:111], v50, s[16:19], s80 offen offset:0 sc1
    v_mfma_f32_16x16x32_bf16 v[220:223], a[168:171], v[76:79], 0
    v_mfma_f32_16x16x32_bf16 v[224:227], a[172:175], v[76:79], 0
    buffer_load_dwordx4 a[104:107], v13, s[16:19], s38 offen offset:2048 sc1
    v_mfma_f32_16x16x32_bf16 v[228:231], a[176:179], v[76:79], 0
    v_mfma_f32_16x16x32_bf16 v[232:235], a[180:183], v[76:79], 0
    s_waitcnt vmcnt(14)
    v_mfma_f32_16x16x32_bf16 v[216:219], a[184:187], v[80:83], v[216:219]
    buffer_load_dwordx4 v[112:115], v50, s[16:19], s81 offen offset:0 sc1
    v_mfma_f32_16x16x32_bf16 v[220:223], a[188:191], v[80:83], v[220:223]
    v_mfma_f32_16x16x32_bf16 v[224:227], a[192:195], v[80:83], v[224:227]
    s_add_u32 s38, s7, 4096
    buffer_load_dwordx4 a[108:111], v13, s[16:19], s38 offen offset:1024 sc1
    v_mfma_f32_16x16x32_bf16 v[228:231], a[196:199], v[80:83], v[228:231]
    v_mfma_f32_16x16x32_bf16 v[232:235], a[200:203], v[80:83], v[232:235]
    s_waitcnt vmcnt(15)
    v_mfma_f32_16x16x32_bf16 v[216:219], a[204:207], v[84:87], v[216:219]
    buffer_load_dwordx4 v[116:119], v50, s[16:19], s82 offen offset:0 sc1
    v_mfma_f32_16x16x32_bf16 v[220:223], a[208:211], v[84:87], v[220:223]
    v_mfma_f32_16x16x32_bf16 v[224:227], a[212:215], v[84:87], v[224:227]
    buffer_load_dwordx4 a[112:115], v13, s[16:19], s38 offen offset:2048 sc1
    v_mfma_f32_16x16x32_bf16 v[228:231], a[216:219], v[84:87], v[228:231]
    v_mfma_f32_16x16x32_bf16 v[232:235], a[220:223], v[84:87], v[232:235]
    s_waitcnt vmcnt(16)
    v_mfma_f32_16x16x32_bf16 v[216:219], a[224:227], v[88:91], v[216:219]
    buffer_load_dwordx4 v[120:123], v50, s[16:19], s83 offen offset:0 sc1
    v_mfma_f32_16x16x32_bf16 v[220:223], a[228:231], v[88:91], v[220:223]
    v_mfma_f32_16x16x32_bf16 v[224:227], a[232:235], v[88:91], v[224:227]
    buffer_load_dwordx4 a[116:119], v13, s[16:19], s38 offen offset:3072 sc1
    v_mfma_f32_16x16x32_bf16 v[228:231], a[236:239], v[88:91], v[228:231]
    v_mfma_f32_16x16x32_bf16 v[232:235], a[240:243], v[88:91], v[232:235]
    s_waitcnt vmcnt(14)
    v_readfirstlane_b32 s97, v17
    s_nop 1
    s_cmp_ge_u32 s97, 8
    s_cbranch_scc1 L_pout25
    s_mov_b32 s3, 0
L_poll24:
    v_mov_b32 v17, 0
    s_mov_b64 exec, 1
    buffer_atomic_add v17, off, s[16:19], s76 sc0 sc1
    s_mov_b64 exec, -1
    s_add_u32 s3, s3, 1
    s_waitcnt vmcnt(0)
    s_cmp_gt_u32 s3, 0x40000
    s_cbranch_scc1 L_pout25
    v_readfirstlane_b32 s97, v17
    s_nop 1
    s_cmp_lt_u32 s97, 8
    s_cbranch_scc1 L_poll24
L_pout25:
    v_mfma_f32_16x16x32_bf16 v[236:239], a[164:167], v[92:95], 0
    buffer_load_dwordx4 v[60:63], v51, s[16:19], s80 offen offset:1024 sc1
    v_mfma_f32_16x16x32_bf16 v[240:243], a[168:171], v[92:95], 0
    v_mfma_f32_16x16x32_bf16 v[244:247], a[172:175], v[92:95], 0
    s_add_u32 s38, s7, 8192
    buffer_load_dwordx4 a[120:123], v13, s[16:19], s38 offen offset:0 sc1
    v_mfma_f32_16x16x32_bf16 v[248:251], a[176:179], v[92:95], 0
    v_mfma_f32_16x16x32_bf16 v[252:255], a[180:183], v[92:95], 0
    s_waitcnt vmcnt(15)
    v_mfma_f32_16x16x32_bf16 v[236:239], a[184:187], v[96:99], v[236:239]
    buffer_load_dwordx4 v[64:67], v51, s[16:19], s80 offen offset:2048 sc1
    v_mfma_f32_16x16x32_bf16 v[240:243], a[188:191], v[96:99], v[240:243]
    v_mfma_f32_16x16x32_bf16 v[244:247], a[192:195], v[96:99], v[244:247]
    buffer_load_dwordx4 a[124:127], v13, s[16:19], s38 offen offset:1024 sc1
    v_mfma_f32_16x16x32_bf16 v[248:251], a[196:199], v[96:99], v[248:251]
    v_mfma_f32_16x16x32_bf16 v[252:255], a[200:203], v[96:99], v[252:255]
    s_waitcnt vmcnt(15)
    v_mfma_f32_16x16x32_bf16 v[236:239], a[204:207], v[100:103], v[236:239]
    buffer_load_dwordx4 v[68:71], v51, s[16:19], s81 offen offset:1024 sc1
    v_mfma_f32_16x16x32_bf16 v[240:243], a[208:211], v[100:103], v[240:243]
    v_mfma_f32_16x16x32_bf16 v[244:247], a[212:215], v[100:103], v[244:247]
    buffer_load_dwordx4 a[128:131], v13, s[16:19], s38 offen offset:2048 sc1
    v_mfma_f32_16x16x32_bf16 v[248:251], a[216:219], v[100:103], v[248:251]
    v_mfma_f32_16x16x32_bf16 v[252:255], a[220:223], v[100:103], v[252:255]
    s_waitcnt vmcnt(15)
    v_mfma_f32_16x16x32_bf16 v[236:239], a[224:227], v[104:107], v[236:239]
    buffer_load_dwordx4 v[72:75], v51, s[16:19], s81 offen offset:2048 sc1
    v_mfma_f32_16x16x32_bf16 v[240:243], a[228:231], v[104:107], v[240:243]
    v_mfma_f32_16x16x32_bf16 v[244:247], a[232:235], v[104:107], v[244:247]
    buffer_load_dwordx4 a[132:135], v13, s[16:19], s38 offen offset:3072 sc1
    v_mfma_f32_16x16x32_bf16 v[248:251], a[236:239], v[104:107], v[248:251]
    v_mfma_f32_16x16x32_bf16 v[252:255], a[240:243], v[104:107], v[252:255]
    s_barrier
    s_waitcnt vmcnt(15)
    v_mfma_f32_16x16x32_bf16 v[176:179], a[164:167], v[108:111], v[176:179]
    buffer_load_dwordx4 v[76:79], v51, s[16:19], s82 offen offset:1024 sc1
    v_mfma_f32_16x16x32_bf16 v[180:183], a[168:171], v[108:111], v[180:183]
    v_mfma_f32_16x16x32_bf16 v[184:187], a[172:175], v[108:111], v[184:187]
    s_add_u32 s38, s7, 12288
    buffer_load_dwordx4 a[136:139], v13, s[16:19], s38 offen offset:0 sc1
    v_mfma_f32_16x16x32_bf16 v[188:191], a[176:179], v[108:111], v[188:191]
    v_mfma_f32_16x16x32_bf16 v[192:195], a[180:183], v[108:111], v[192:195]
    s_waitcnt vmcnt(15)
    v_mfma_f32_16x16x32_bf16 v[176:179], a[184:187], v[112:115], v[176:179]
    buffer_load_dwordx4 v[80:83], v51, s[16:19], s82 offen offset:2048 sc1
    v_mfma_f32_16x16x32_bf16 v[180:183], a[188:191], v[112:115], v[180:183]
    v_mfma_f32_16x16x32_bf16 v[184:187], a[192:195], v[112:115], v[184:187]
    buffer_load_dwordx4 a[140:143], v13, s[16:19], s38 offen offset:1024 sc1
    v_mfma_f32_16x16x32_bf16 v[188:191], a[196:199], v[112:115], v[188:191]
    v_mfma_f32_16x16x32_bf16 v[192:195], a[200:203], v[112:115], v[192:195]
    s_waitcnt vmcnt(15)
    v_mfma_f32_16x16x32_bf16 v[176:179], a[204:207], v[116:119], v[176:179]
    buffer_load_dwordx4 v[84:87], v51, s[16:19], s83 offen offset:1024 sc1
    v_mfma_f32_16x16x32_bf16 v[180:183], a[208:211], v[116:119], v[180:183]
    v_mfma_f32_16x16x32_bf16 v[184:187], a[212:215], v[116:119], v[184:187]
    buffer_load_dwordx4 a[144:147], v13, s[16:19], s38 offen offset:2048 sc1
    v_mfma_f32_16x16x32_bf16 v[188:191], a[216:219], v[116:119], v[188:191]
    v_mfma_f32_16x16x32_bf16 v[192:195], a[220:223], v[116:119], v[192:195]
    s_waitcnt vmcnt(15)
    v_mfma_f32_16x16x32_bf16 v[176:179], a[224:227], v[120:123], v[176:179]
    buffer_load_dwordx4 v[88:91], v51, s[16:19], s83 offen offset:2048 sc1
    v_mfma_f32_16x16x32_bf16 v[180:183], a[228:231], v[120:123], v[180:183]
    v_mfma_f32_16x16x32_bf16 v[184:187], a[232:235], v[120:123], v[184:187]
    v_mfma_f32_16x16x32_bf16 v[188:191], a[236:239], v[120:123], v[188:191]
    v_mfma_f32_16x16x32_bf16 v[192:195], a[240:243], v[120:123], v[192:195]
    s_waitcnt vmcnt(14)
    v_mfma_f32_16x16x32_bf16 v[196:199], a[244:247], v[60:63], v[196:199]
    buffer_load_dwordx4 v[92:95], v52, s[16:19], s80 offen offset:1024 sc1
    v_mfma_f32_16x16x32_bf16 v[200:203], a[248:251], v[60:63], v[200:203]
    v_mfma_f32_16x16x32_bf16 v[204:207], a[252:255], v[60:63], v[204:207]
    v_mfma_f32_16x16x32_bf16 v[208:211], a[0:3], v[60:63], v[208:211]
    v_mfma_f32_16x16x32_bf16 v[212:215], a[4:7], v[60:63], v[212:215]
    s_waitcnt vmcnt(13)
    v_mfma_f32_16x16x32_bf16 v[196:199], a[8:11], v[64:67], v[196:199]
    buffer_load_dwordx4 v[96:99], v52, s[16:19], s80 offen offset:2048 sc1
    v_mfma_f32_16x16x32_bf16 v[200:203], a[12:15], v[64:67], v[200:203]
    v_mfma_f32_16x16x32_bf16 v[204:207], a[16:19], v[64:67], v[204:207]
    v_mfma_f32_16x16x32_bf16 v[208:211], a[20:23], v[64:67], v[208:211]
    v_mfma_f32_16x16x32_bf16 v[212:215], a[24:27], v[64:67], v[212:215]
    s_waitcnt vmcnt(12)
    v_mfma_f32_16x16x32_bf16 v[196:199], a[28:31], v[68:71], v[196:199]
    buffer_load_dwordx4 v[100:103], v52, s[16:19], s81 offen offset:1024 sc1
    v_mfma_f32_16x16x32_bf16 v[200:203], a[32:35], v[68:71], v[200:203]
    v_mfma_f32_16x16x32_bf16 v[204:207], a[36:39], v[68:71], v[204:207]
    v_mfma_f32_16x16x32_bf16 v[208:211], a[40:43], v[68:71], v[208:211]
    v_mfma_f32_16x16x32_bf16 v[212:215], a[44:47], v[68:71], v[212:215]
    s_waitcnt vmcnt(11)
    v_mfma_f32_16x16x32_bf16 v[196:199], a[48:51], v[72:75], v[196:199]
    buffer_load_dwordx4 v[104:107], v52, s[16:19], s81 offen offset:2048 sc1
    v_mfma_f32_16x16x32_bf16 v[200:203], a[52:55], v[72:75], v[200:203]
    v_mfma_f32_16x16x32_bf16 v[204:207], a[56:59], v[72:75], v[204:207]
    v_mfma_f32_16x16x32_bf16 v[208:211], a[60:63], v[72:75], v[208:211]
    v_mfma_f32_16x16x32_bf16 v[212:215], a[64:67], v[72:75], v[212:215]
    s_waitcnt vmcnt(10)
    v_mfma_f32_16x16x32_bf16 v[196:199], a[68:71], v[76:79], v[196:199]
    buffer_load_dwordx4 v[108:111], v52, s[16:19], s82 offen offset:1024 sc1
    v_mfma_f32_16x16x32_bf16 v[200:203], a[72:75], v[76:79], v[200:203]
    v_mfma_f32_16x16x32_bf16 v[204:207], a[76:79], v[76:79], v[204:207]
    v_mfma_f32_16x16x32_bf16 v[208:211], a[80:83], v[76:79], v[208:211]
    v_mfma_f32_16x16x32_bf16 v[212:215], a[84:87], v[76:79], v[212:215]
    s_waitcnt vmcnt(9)
    v_mfma_f32_16x16x32_bf16 v[196:199], a[88:91], v[80:83], v[196:199]
    buffer_load_dwordx4 v[112:115], v52, s[16:19], s82 offen offset:2048 sc1
    v_mfma_f32_16x16x32_bf16 v[200:203], a[92:95], v[80:83], v[200:203]
    v_mfma_f32_16x16x32_bf16 v[204:207], a[96:99], v[80:83], v[204:207]
    v_mfma_f32_16x16x32_bf16 v[208:211], a[100:103], v[80:83], v[208:211]
    v_mfma_f32_16x16x32_bf16 v[212:215], a[104:107], v[80:83], v[212:215]
    s_waitcnt vmcnt(8)
    v_mfma_f32_16x16x32_bf16 v[196:199], a[108:111], v[84:87], v[196:199]
    buffer_load_dwordx4 v[116:119], v52, s[16:19], s83 offen offset:1024 sc1
    v_mfma_f32_16x16x32_bf16 v[200:203], a[112:115], v[84:87], v[200:203]
    v_mfma_f32_16x16x32_bf16 v[204:207], a[116:119], v[84:87], v[204:207]
    v_mfma_f32_16x16x32_bf16 v[208:211], a[120:123], v[84:87], v[208:211]
    v_mfma_f32_16x16x32_bf16 v[212:215], a[124:127], v[84:87], v[212:215]
    s_waitcnt vmcnt(7)
    v_mfma_f32_16x16x32_bf16 v[196:199], a[128:131], v[88:91], v[196:199]
    buffer_load_dwordx4 v[120:123], v52, s[16:19], s83 offen offset:2048 sc1
    v_mfma_f32_16x16x32_bf16 v[200:203], a[132:135], v[88:91], v[200:203]
    v_mfma_f32_16x16x32_bf16 v[204:207], a[136:139], v[88:91], v[204:207]
    v_mfma_f32_16x16x32_bf16 v[208:211], a[140:143], v[88:91], v[208:211]
    v_mfma_f32_16x16x32_bf16 v[212:215], a[144:147], v[88:91], v[212:215]
    s_waitcnt vmcnt(7)
    v_mfma_f32_16x16x32_bf16 v[216:219], a[244:247], v[92:95], v[216:219]
    buffer_load_dwordx4 v[60:63], v53, s[16:19], s80 offen offset:1024 sc1
    v_mfma_f32_16x16x32_bf16 v[220:223], a[248:251], v[92:95], v[220:223]
    v_mfma_f32_16x16x32_bf16 v[224:227], a[252:255], v[92:95], v[224:227]
    ds_write_b128 v55, v[196:199] offset:0
    v_mfma_f32_16x16x32_bf16 v[228:231], a[0:3], v[92:95], v[228:231]
    v_mfma_f32_16x16x32_bf16 v[232:235], a[4:7], v[92:95], v[232:235]
    s_waitcnt vmcnt(7)
    v_mfma_f32_16x16x32_bf16 v[216:219], a[8:11], v[96:99], v[216:219]
    buffer_load_dwordx4 v[64:67], v53, s[16:19], s80 offen offset:2048 sc1
    ds_write_b128 v55, v[200:203] offset:1024
    v_mfma_f32_16x16x32_bf16 v[220:223], a[12:15], v[96:99], v[220:223]
    v_mfma_f32_16x16x32_bf16 v[224:227], a[16:19], v[96:99], v[224:227]
    v_mfma_f32_16x16x32_bf16 v[228:231], a[20:23], v[96:99], v[228:231]
    ds_write_b128 v55, v[204:207] offset:2048
    v_mfma_f32_16x16x32_bf16 v[232:235], a[24:27], v[96:99], v[232:235]
    s_waitcnt vmcnt(7)
    v_mfma_f32_16x16x32_bf16 v[216:219], a[28:31], v[100:103], v[216:219]
    buffer_load_dwordx4 v[68:71], v53, s[16:19], s81 offen offset:1024 sc1
    v_mfma_f32_16x16x32_bf16 v[220:223], a[32:35], v[100:103], v[220:223]
    ds_write_b128 v55, v[208:211] offset:3072
    v_mfma_f32_16x16x32_bf16 v[224:227], a[36:39], v[100:103], v[224:227]
    v_mfma_f32_16x16x32_bf16 v[228:231], a[40:43], v[100:103], v[228:231]
    v_mfma_f32_16x16x32_bf16 v[232:235], a[44:47], v[100:103], v[232:235]
    ds_write_b128 v55, v[212:215] offset:4096
    s_waitcnt vmcnt(7)
    v_mfma_f32_16x16x32_bf16 v[216:219], a[48:51], v[104:107], v[216:219]
    buffer_load_dwordx4 v[72:75], v53, s[16:19], s81 offen offset:2048 sc1
    v_mfma_f32_16x16x32_bf16 v[220:223], a[52:55], v[104:107], v[220:223]
    v_mfma_f32_16x16x32_bf16 v[224:227], a[56:59], v[104:107], v[224:227]
    v_mfma_f32_16x16x32_bf16 v[228:231], a[60:63], v[104:107], v[228:231]
    v_mfma_f32_16x16x32_bf16 v[232:235], a[64:67], v[104:107], v[232:235]
    s_waitcnt vmcnt(7)
    v_mfma_f32_16x16x32_bf16 v[216:219], a[68:71], v[108:111], v[216:219]
    buffer_load_dwordx4 v[76:79], v53, s[16:19], s82 offen offset:1024 sc1
    v_mfma_f32_16x16x32_bf16 v[220:223], a[72:75], v[108:111], v[220:223]
    v_mfma_f32_16x16x32_bf16 v[224:227], a[76:79], v[108:111], v[224:227]
    v_mfma_f32_16x16x32_bf16 v[228:231], a[80:83], v[108:111], v[228:231]
    v_mfma_f32_16x16x32_bf16 v[232:235], a[84:87], v[108:111], v[232:235]
    s_waitcnt vmcnt(7)
    v_mfma_f32_16x16x32_bf16 v[216:219], a[88:91], v[112:115], v[216:219]
    buffer_load_dwordx4 v[80:83], v53, s[16:19], s82 offen offset:2048 sc1
    v_mfma_f32_16x16x32_bf16 v[220:223], a[92:95], v[112:115], v[220:223]
    v_mfma_f32_16x16x32_bf16 v[224:227], a[96:99], v[112:115], v[224:227]
    v_mfma_f32_16x16x32_bf16 v[228:231], a[100:103], v[112:115], v[228:231]
L_pad6:
    s_cbranch_execz L_padret
    v_mfma_f32_16x16x32_bf16 v[232:235], a[104:107], v[112:115], v[232:235]
    s_waitcnt vmcnt(7)
    v_mfma_f32_16x16x32_bf16 v[216:219], a[108:111], v[116:119], v[216:219]
    buffer_load_dwordx4 v[84:87], v53, s[16:19], s83 offen offset:1024 sc1
    v_mfma_f32_16x16x32_bf16 v[220:223], a[112:115], v[116:119], v[220:223]
    v_mfma_f32_16x16x32_bf16 v[224:227], a[116:119], v[116:119], v[224:227]
    v_mfma_f32_16x16x32_bf16 v[228:231], a[120:123], v[116:119], v[228:231]
    v_mfma_f32_16x16x32_bf16 v[232:235], a[124:127], v[116:119], v[232:235]
    s_waitcnt vmcnt(7)
    v_mfma_f32_16x16x32_bf16 v[216:219], a[128:131], v[120:123], v[216:219]
    buffer_load_dwordx4 v[88:91], v53, s[16:19], s83 offen offset:2048 sc1
    v_mfma_f32_16x16x32_bf16 v[220:223], a[132:135], v[120:123], v[220:223]
    v_mfma_f32_16x16x32_bf16 v[224:227], a[136:139], v[120:123], v[224:227]
    v_mfma_f32_16x16x32_bf16 v[228:231], a[140:143], v[120:123], v[228:231]
    v_mfma_f32_16x16x32_bf16 v[232:235], a[144:147], v[120:123], v[232:235]
    s_waitcnt vmcnt(7)
    v_mfma_f32_16x16x32_bf16 v[236:239], a[244:247], v[60:63], v[236:239]
    buffer_load_dwordx4 v[92:95], v50, s[16:19], s80 offen offset:1024 sc1
    v_mfma_f32_16x16x32_bf16 v[240:243], a[248:251], v[60:63], v[240:243]
    v_mfma_f32_16x16x32_bf16 v[244:247], a[252:255], v[60:63], v[244:247]
    ds_write_b128 v56, v[216:219] offset:5120
    v_mfma_f32_16x16x32_bf16 v[248:251], a[0:3], v[60:63], v[248:251]
    v_mfma_f32_16x16x32_bf16 v[252:255], a[4:7], v[60:63], v[252:255]
    s_waitcnt vmcnt(7)
    v_mfma_f32_16x16x32_bf16 v[236:239], a[8:11], v[64:67], v[236:239]
    buffer_load_dwordx4 v[96:99], v50, s[16:19], s80 offen offset:2048 sc1
    ds_write_b128 v56, v[220:223] offset:6144
    v_mfma_f32_16x16x32_bf16 v[240:243], a[12:15], v[64:67], v[240:243]
    v_mfma_f32_16x16x32_bf16 v[244:247], a[16:19], v[64:67], v[244:247]
    v_mfma_f32_16x16x32_bf16 v[248:251], a[20:23], v[64:67], v[248:251]
    ds_write_b128 v56, v[224:227] offset:7168
    v_mfma_f32_16x16x32_bf16 v[252:255], a[24:27], v[64:67], v[252:255]
    s_waitcnt vmcnt(7)
    v_mfma_f32_16x16x32_bf16 v[236:239], a[28:31], v[68:71], v[236:239]
    buffer_load_dwordx4 v[100:103], v50, s[16:19], s81 offen offset:1024 sc1
    v_mfma_f32_16x16x32_bf16 v[240:243], a[32:35], v[68:71], v[240:243]
    ds_write_b128 v56, v[228:231] offset:8192
    v_mfma_f32_16x16x32_bf16 v[244:247], a[36:39], v[68:71], v[244:247]
    v_mfma_f32_16x16x32_bf16 v[248:251], a[40:43], v[68:71], v[248:251]
    v_mfma_f32_16x16x32_bf16 v[252:255], a[44:47], v[68:71], v[252:255]
    ds_write_b128 v56, v[232:235] offset:9216
    s_waitcnt vmcnt(7)
    v_mfma_f32_16x16x32_bf16 v[236:239], a[48:51], v[72:75], v[236:239]
    buffer_load_dwordx4 v[104:107], v50, s[16:19], s81 offen offset:2048 sc1
    v_mfma_f32_16x16x32_bf16 v[240:243], a[52:55], v[72:75], v[240:243]
    v_mfma_f32_16x16x32_bf16 v[244:247], a[56:59], v[72:75], v[244:247]
    v_mfma_f32_16x16x32_bf16 v[248:251], a[60:63], v[72:75], v[248:251]
    v_mfma_f32_16x16x32_bf16 v[252:255], a[64:67], v[72:75], v[252:255]
    s_waitcnt lgkmcnt(0)
    s_barrier
    s_waitcnt vmcnt(7)
    v_mfma_f32_16x16x32_bf16 v[236:239], a[68:71], v[76:79], v[236:239]
    buffer_load_dwordx4 v[108:111], v50, s[16:19], s82 offen offset:1024 sc1
    ds_read_b128 v[196:199], v54 offset:0
    ds_read_b128 v[200:203], v54 offset:1024
    v_mfma_f32_16x16x32_bf16 v[240:243], a[72:75], v[76:79], v[240:243]
    ds_read_b128 v[204:207], v54 offset:2048
    ds_read_b128 v[208:211], v54 offset:3072
    v_mfma_f32_16x16x32_bf16 v[244:247], a[76:79], v[76:79], v[244:247]
    ds_read_b128 v[212:215], v54 offset:4096
    ds_read_b128 v[216:219], v54 offset:5120
    v_mfma_f32_16x16x32_bf16 v[248:251], a[80:83], v[76:79], v[248:251]
    ds_read_b128 v[220:223], v54 offset:6144
    ds_read_b128 v[224:227], v54 offset:7168
    v_mfma_f32_16x16x32_bf16 v[252:255], a[84:87], v[76:79], v[252:255]
    ds_read_b128 v[228:231], v54 offset:8192
    ds_read_b128 v[232:235], v54 offset:9216
    s_waitcnt vmcnt(7)
    v_mfma_f32_16x16x32_bf16 v[236:239], a[88:91], v[80:83], v[236:239]
    buffer_load_dwordx4 v[112:115], v50, s[16:19], s82 offen offset:2048 sc1
    v_mfma_f32_16x16x32_bf16 v[240:243], a[92:95], v[80:83], v[240:243]
    v_mfma_f32_16x16x32_bf16 v[244:247], a[96:99], v[80:83], v[244:247]
    s_waitcnt lgkmcnt(4)
    v_add_f32 v196, v196, v216
    v_add_f32 v197, v197, v217
    v_mfma_f32_16x16x32_bf16 v[248:251], a[100:103], v[80:83], v[248:251]
    v_add_f32 v198, v198, v218
    v_add_f32 v199, v199, v219
    v_mfma_f32_16x16x32_bf16 v[252:255], a[104:107], v[80:83], v[252:255]
    s_waitcnt lgkmcnt(3)
    v_add_f32 v200, v200, v220
    v_add_f32 v201, v201, v221
    s_waitcnt vmcnt(7)
    v_mfma_f32_16x16x32_bf16 v[236:239], a[108:111], v[84:87], v[236:239]
    buffer_load_dwordx4 v[116:119], v50, s[16:19], s83 offen offset:1024 sc1
    v_add_f32 v202, v202, v222
    v_add_f32 v203, v203, v223
    v_mfma_f32_16x16x32_bf16 v[240:243], a[112:115], v[84:87], v[240:243]
    s_waitcnt lgkmcnt(2)
    v_add_f32 v204, v204, v224
    v_add_f32 v205, v205, v225
    v_mfma_f32_16x16x32_bf16 v[244:247], a[116:119], v[84:87], v[244:247]
    v_add_f32 v206, v206, v226
    v_add_f32 v207, v207, v227
    v_mfma_f32_16x16x32_bf16 v[248:251], a[120:123], v[84:87], v[248:251]
    s_waitcnt lgkmcnt(1)
    v_add_f32 v208, v208, v228
    v_add_f32 v209, v209, v229
    v_mfma_f32_16x16x32_bf16 v[252:255], a[124:127], v[84:87], v[252:255]
    v_add_f32 v210, v210, v230
    v_add_f32 v211, v211, v231
    s_waitcnt vmcnt(7)
    v_mfma_f32_16x16x32_bf16 v[236:239], a[128:131], v[88:91], v[236:239]
    buffer_load_dwordx4 v[120:123], v50, s[16:19], s83 offen offset:2048 sc1
    s_waitcnt lgkmcnt(0)
    v_add_f32 v212, v212, v232
    v_add_f32 v213, v213, v233
    v_mfma_f32_16x16x32_bf16 v[240:243], a[132:135], v[88:91], v[240:243]
    v_add_f32 v214, v214, v234
    v_add_f32 v215, v215, v235
    v_mfma_f32_16x16x32_bf16 v[244:247], a[136:139], v[88:91], v[244:247]
    v_mfma_f32_16x16x32_bf16 v[248:251], a[140:143], v[88:91], v[248:251]
    v_mfma_f32_16x16x32_bf16 v[252:255], a[144:147], v[88:91], v[252:255]
    s_waitcnt vmcnt(7)
    v_mfma_f32_16x16x32_bf16 v[176:179], a[244:247], v[92:95], v[176:179]
    v_mfma_f32_16x16x32_bf16 v[180:183], a[248:251], v[92:95], v[180:183]
    v_mfma_f32_16x16x32_bf16 v[184:187], a[252:255], v[92:95], v[184:187]
    ds_write_b128 v57, v[236:239] offset:10240
    v_mfma_f32_16x16x32_bf16 v[188:191], a[0:3], v[92:95], v[188:191]
    v_mfma_f32_16x16x32_bf16 v[192:195], a[4:7], v[92:95], v[192:195]
    s_waitcnt vmcnt(6)
    v_mfma_f32_16x16x32_bf16 v[176:179], a[8:11], v[96:99], v[176:179]
    ds_write_b128 v57, v[240:243] offset:11264
    v_mfma_f32_16x16x32_bf16 v[180:183], a[12:15], v[96:99], v[180:183]
    v_mfma_f32_16x16x32_bf16 v[184:187], a[16:19], v[96:99], v[184:187]
    v_mfma_f32_16x16x32_bf16 v[188:191], a[20:23], v[96:99], v[188:191]
    ds_write_b128 v57, v[244:247] offset:12288
    v_mfma_f32_16x16x32_bf16 v[192:195], a[24:27], v[96:99], v[192:195]
    s_waitcnt vmcnt(5)
    v_mfma_f32_16x16x32_bf16 v[176:179], a[28:31], v[100:103], v[176:179]
    v_mfma_f32_16x16x32_bf16 v[180:183], a[32:35], v[100:103], v[180:183]
    ds_write_b128 v57, v[248:251] offset:13312
    v_mfma_f32_16x16x32_bf16 v[184:187], a[36:39], v[100:103], v[184:187]
    v_mfma_f32_16x16x32_bf16 v[188:191], a[40:43], v[100:103], v[188:191]
    v_mfma_f32_16x16x32_bf16 v[192:195], a[44:47], v[100:103], v[192:195]
    ds_write_b128 v57, v[252:255] offset:14336
    s_waitcnt vmcnt(4)
    v_mfma_f32_16x16x32_bf16 v[176:179], a[48:51], v[104:107], v[176:179]
    v_mfma_f32_16x16x32_bf16 v[180:183], a[52:55], v[104:107], v[180:183]
    v_mfma_f32_16x16x32_bf16 v[184:187], a[56:59], v[104:107], v[184:187]
    v_mfma_f32_16x16x32_bf16 v[188:191], a[60:63], v[104:107], v[188:191]
    s_waitcnt lgkmcnt(0)
    s_barrier
    v_mfma_f32_16x16x32_bf16 v[192:195], a[64:67], v[104:107], v[192:195]
    ds_read_b128 v[236:239], v54 offset:10240
    ds_read_b128 v[240:243], v54 offset:11264
    s_waitcnt vmcnt(3)
    v_mfma_f32_16x16x32_bf16 v[176:179], a[68:71], v[108:111], v[176:179]
    ds_read_b128 v[244:247], v54 offset:12288
    ds_read_b128 v[248:251], v54 offset:13312
    v_mfma_f32_16x16x32_bf16 v[180:183], a[72:75], v[108:111], v[180:183]
    ds_read_b128 v[252:255], v54 offset:14336
    v_mfma_f32_16x16x32_bf16 v[184:187], a[76:79], v[108:111], v[184:187]
    v_mfma_f32_16x16x32_bf16 v[188:191], a[80:83], v[108:111], v[188:191]
    v_mfma_f32_16x16x32_bf16 v[192:195], a[84:87], v[108:111], v[192:195]
    s_waitcnt vmcnt(2)
    v_mfma_f32_16x16x32_bf16 v[176:179], a[88:91], v[112:115], v[176:179]
    v_mfma_f32_16x16x32_bf16 v[180:183], a[92:95], v[112:115], v[180:183]
    s_waitcnt lgkmcnt(4)
    v_add_f32 v196, v196, v236
    v_add_f32 v197, v197, v237
    v_mfma_f32_16x16x32_bf16 v[184:187], a[96:99], v[112:115], v[184:187]
    v_add_f32 v198, v198, v238
    v_add_f32 v199, v199, v239
    v_mfma_f32_16x16x32_bf16 v[188:191], a[100:103], v[112:115], v[188:191]
    s_waitcnt lgkmcnt(3)
    v_add_f32 v200, v200, v240
    v_add_f32 v201, v201, v241
    v_mfma_f32_16x16x32_bf16 v[192:195], a[104:107], v[112:115], v[192:195]
    v_add_f32 v202, v202, v242
    v_add_f32 v203, v203, v243
    s_waitcnt vmcnt(1)
    v_mfma_f32_16x16x32_bf16 v[176:179], a[108:111], v[116:119], v[176:179]
    s_waitcnt lgkmcnt(2)
    v_add_f32 v204, v204, v244
    v_add_f32 v205, v205, v245
    v_mfma_f32_16x16x32_bf16 v[180:183], a[112:115], v[116:119], v[180:183]
    v_add_f32 v206, v206, v246
    v_add_f32 v207, v207, v247
    v_mfma_f32_16x16x32_bf16 v[184:187], a[116:119], v[116:119], v[184:187]
    s_waitcnt lgkmcnt(1)
    v_add_f32 v208, v208, v248
    v_add_f32 v209, v209, v249
    v_mfma_f32_16x16x32_bf16 v[188:191], a[120:123], v[116:119], v[188:191]
    v_add_f32 v210, v210, v250
    v_add_f32 v211, v211, v251
    v_mfma_f32_16x16x32_bf16 v[192:195], a[124:127], v[116:119], v[192:195]
    s_waitcnt lgkmcnt(0)
    v_add_f32 v212, v212, v252
    v_add_f32 v213, v213, v253
    s_waitcnt vmcnt(0)
    v_mfma_f32_16x16x32_bf16 v[176:179], a[128:131], v[120:123], v[176:179]
    v_add_f32 v214, v214, v254
    v_add_f32 v215, v215, v255
    v_mfma_f32_16x16x32_bf16 v[180:183], a[132:135], v[120:123], v[180:183]
    v_mfma_f32_16x16x32_bf16 v[184:187], a[136:139], v[120:123], v[184:187]
    v_mfma_f32_16x16x32_bf16 v[188:191], a[140:143], v[120:123], v[188:191]
    v_mfma_f32_16x16x32_bf16 v[192:195], a[144:147], v[120:123], v[192:195]
    s_nop 1
    v_pk_add_f32 v[176:177], v[176:177], v[196:197]
    v_cvt_pk_bf16_f32 v60, v176, v177
    v_pk_add_f32 v[178:179], v[178:179], v[198:199]
    v_cvt_pk_bf16_f32 v61, v178, v179
    ds_write_b64 v34, v[60:61] offset:0
    v_pk_add_f32 v[180:181], v[180:181], v[200:201]
    v_cvt_pk_bf16_f32 v62, v180, v181
    v_pk_add_f32 v[182:183], v[182:183], v[202:203]
    v_cvt_pk_bf16_f32 v63, v182, v183
    ds_write_b64 v34, v[62:63] offset:32
    v_pk_add_f32 v[184:185], v[184:185], v[204:205]
    v_cvt_pk_bf16_f32 v64, v184, v185
    v_pk_add_f32 v[186:187], v[186:187], v[206:207]
    v_cvt_pk_bf16_f32 v65, v186, v187
    ds_write_b64 v34, v[64:65] offset:64
    v_pk_add_f32 v[188:189], v[188:189], v[208:209]
    v_cvt_pk_bf16_f32 v66, v188, v189
    v_pk_add_f32 v[190:191], v[190:191], v[210:211]
    v_cvt_pk_bf16_f32 v67, v190, v191
    ds_write_b64 v34, v[66:67] offset:96
    v_pk_add_f32 v[192:193], v[192:193], v[212:213]
    v_cvt_pk_bf16_f32 v68, v192, v193
    v_pk_add_f32 v[194:195], v[194:195], v[214:215]
    v_cvt_pk_bf16_f32 v69, v194, v195
    ds_write_b64 v34, v[68:69] offset:128
    ds_read_b128 v[196:199], v35
    ds_read_b128 v[200:203], v36
    ds_read_b128 v[204:207], v37
    s_waitcnt lgkmcnt(2)
    buffer_store_dwordx4 v[196:199], v38, s[32:35], s74 offen
    s_waitcnt lgkmcnt(1)
    buffer_store_dwordx4 v[200:203], v39, s[32:35], s74 offen
    s_mov_b32 exec_hi, 0
    s_waitcnt lgkmcnt(0)
    buffer_store_dwordx4 v[204:207], v40, s[32:35], s74 offen
    s_mov_b64 exec, -1
L_fin:
L_end:
    s_endpgm
.section .rodata,"a"
.p2align 6
.amdhsa_kernel sequential_preLN__linear_kernel_hedgehog__mixer_channel_mlp__prompt_kernel
  .amdhsa_next_free_vgpr 512
  .amdhsa_next_free_sgpr 102
  .amdhsa_accum_offset 256
  .amdhsa_group_segment_fixed_size 0
  .amdhsa_kernarg_size 96
  .amdhsa_user_sgpr_count 2
  .amdhsa_user_sgpr_kernarg_segment_ptr 1
  .amdhsa_system_sgpr_workgroup_id_x 1
.end_amdhsa_kernel
```
